```python
import torch

def _softmax(x, axis=-1):
    return torch.softmax(x, dim=axis)
def _gelu(x):
    return torch.nn.functional.gelu(x, approximate="tanh")
def _silu(x):
    return torch.nn.functional.silu(x)
def _sigmoid(x):
    return torch.sigmoid(x)
def _layernorm(x, axis=-1, eps=1e-5):
    m = x.mean(dim=axis, keepdim=True)
    v = x.var(dim=axis, keepdim=True, unbiased=False)
    return (x - m) / torch.sqrt(v + eps)
def _scatter_add(tgt, idx, src, axis=0):
    return tgt.clone().index_add_(axis, idx, src)
def _segment_sum(src, seg, n):
    out = torch.zeros((n,) + src.shape[1:], dtype=src.dtype)
    return out.index_add_(0, seg, src)
def _pad(x, pw):
    flat = tuple(v for pair in reversed(pw) for v in pair)
    return torch.nn.functional.pad(x, flat)

kernel_name = 'sequential_preLN__mha_block_cached__mixer_channel_mlp__decode'

def setup_inputs():

    _w = (lambda a: (lambda t: t.to(torch.bfloat16) if t.is_floating_point() else t)(torch.as_tensor(a)))
    def _A_setup():
        B, Sq, D = 8, 1, 448
        H, Sk, Dh = 16, 4096, 256
        return {
            "x": _w((lambda *s: torch.randn(*s, dtype=torch.bfloat16) * 0.05)(B, Sq, D)),
            "k_cache": _w((lambda *s: torch.randn(*s, dtype=torch.bfloat16) * 3.2)(B, H, Sk, Dh)),
            "v_cache": _w((lambda *s: torch.randn(*s, dtype=torch.bfloat16) * 0.4)(B, H, Sk, Dh)),
            "wq": _w((lambda *s: torch.randn(*s, dtype=torch.bfloat16) * 3.2)(D, H * Dh) * (D ** -0.5)),
            "wo": _w((lambda *s: torch.randn(*s, dtype=torch.bfloat16) * 0.4)(H * Dh, D) * ((H * Dh) ** -0.5)),
        }
    _A_in = _A_setup()

    def _B_setup():
        B, S, D, F = 8, 1, 448, 1792
        return {
            "x": _w((lambda *s: torch.randn(*s, dtype=torch.bfloat16) * 0.05)(B, S, D)),
            "w1": _w((lambda *s: torch.randn(*s, dtype=torch.bfloat16) * 3.2)(D, F) * (D ** -0.5)),
            "b1": _w((lambda *s: torch.randn(*s, dtype=torch.bfloat16) * 1.6)(F)),
            "w2": _w((lambda *s: torch.randn(*s, dtype=torch.bfloat16) * 0.8)(F, D) * (F ** -0.5)),
            "b2": _w((lambda *s: torch.randn(*s, dtype=torch.bfloat16) * 1.6)(D)),
        }
    _B_in = _B_setup()

    return {
        "A_x": _A_in["x"],
        "A_k_cache": _A_in["k_cache"],
        "A_v_cache": _A_in["v_cache"],
        "A_wq": _A_in["wq"],
        "A_wo": _A_in["wo"],
        "B_x": _B_in["x"],
        "B_w1": _B_in["w1"],
        "B_b1": _B_in["b1"],
        "B_w2": _B_in["w2"],
        "B_b2": _B_in["b2"],
    }

def reference(A_x, A_k_cache, A_v_cache, A_wq, A_wo, B_x, B_w1, B_b1, B_w2, B_b2):
    def _A_ref(x, k_cache, v_cache, wq, wo):
        B, Sq, D = x.shape
        H, Dh = 16, 256
        q = (lambda x, *d: x.permute(*d))((x @ wq).reshape(B, Sq, H, Dh), 0, 2, 1, 3)
        scores = torch.einsum("bhqd,bhkd->bhqk", q, k_cache) * (Dh ** -0.5)
        p = _softmax(scores, axis=-1)
        o = torch.einsum("bhqk,bhkd->bhqd", p, v_cache)
        return (lambda x, *d: x.permute(*d))(o, 0, 2, 1, 3).reshape(B, Sq, H * Dh) @ wo

    def _B_ref(x, w1, b1, w2, b2):
        y = _layernorm(x, axis=-1)
        h = _gelu(torch.einsum("bsd,df->bsf", y, w1) + b1)
        return torch.einsum("bsf,fd->bsd", h, w2) + b2

    x = A_x
    h = x + _A_ref(_layernorm(x, axis=-1), A_k_cache, A_v_cache, A_wq, A_wo)
    h2 = h + _B_ref(_layernorm(h, axis=-1), B_w1, B_b1, B_w2, B_b2)
    return h2
```

```asm
; @launch grid=(256,1,1) block=(512,1,1) lds=120192
.amdgcn_target "amdgcn-amd-amdhsa--gfx950"
.text
.globl sequential_preLN__mha_block_cached__mixer_channel_mlp__decode_kernel
.p2align 8
.type sequential_preLN__mha_block_cached__mixer_channel_mlp__decode_kernel,@function
sequential_preLN__mha_block_cached__mixer_channel_mlp__decode_kernel:
    s_cmp_ge_u32 s2, 256
    s_cbranch_scc1 L_end
    s_load_dwordx16 s[16:31], s[0:1], 0
    s_load_dwordx8 s[32:39], s[0:1], 64
    s_load_dwordx2 s[40:41], s[0:1], 96
    v_lshrrev_b32 v1, 6, v0
    v_and_b32 v0, 63, v0
    v_readfirstlane_b32 s3, v1
    s_and_b32 s5, s2, 15
    s_lshr_b32 s7, s2, 5
    s_lshl4_add_u32 s12, s7, s5
    s_lshl_b32 s13, s12, 21
    s_and_b32 s9, s3, 3
    s_and_b32 s12, s2, 16
    s_lshl1_add_u32 s12, s9, s12
    s_lshl_b32 s69, s12, 11
    s_cmp_ge_u32 s3, 4
    s_cbranch_scc1 L_vwave
    v_bfe_u32 v1, v0, 2, 2
    v_lshlrev_b32 v1, 9, v1
    v_and_b32 v2, 3, v0
    v_lshrrev_b32 v3, 4, v0
    v_lshl_add_u32 v2, v3, 2, v2
    v_lshl_add_u32 v1, v2, 4, v1
    s_waitcnt lgkmcnt(0)
    s_add_u32 s44, s18, s13
    s_addc_u32 s45, s19, 0
    s_mov_b32 s46, 2097152
    s_mov_b32 s47, 0x20000
    buffer_load_dwordx4 v[32:35], v1, s[44:47], s69 offen offset:0 nt
    buffer_load_dwordx4 v[36:39], v1, s[44:47], s69 offen offset:256 nt
    buffer_load_dwordx4 v[40:43], v1, s[44:47], s69 offen offset:2048 nt
    buffer_load_dwordx4 v[44:47], v1, s[44:47], s69 offen offset:2304 nt
    s_add_u32 s70, s69, 16384
    s_bfe_u32 s6, s2, 0x10004
    s_and_b32 s8, s2, 31
    s_and_b32 s10, s2, 31
    buffer_load_dwordx4 v[48:51], v1, s[44:47], s70 offen offset:0 nt
    buffer_load_dwordx4 v[52:55], v1, s[44:47], s70 offen offset:256 nt
    s_lshl_b32 s12, s9, 2
    v_mov_b32 v27, s12
    v_mov_b32 v29, 0
    v_mov_b32 v28, 0
    s_mov_b32 s76, 12
    ds_write_b32 v29, v29 offset:46416
    v_mov_b32 v30, 12
    ds_write_b32 v27, v30 offset:46400
    s_waitcnt vmcnt(5)
    buffer_load_dwordx4 v[56:59], v1, s[44:47], s70 offen offset:2048 nt
    s_waitcnt vmcnt(5)
    buffer_load_dwordx4 v[60:63], v1, s[44:47], s70 offen offset:2304 nt
    s_add_u32 s69, s69, 65536
    s_add_u32 s70, s70, 65536
    s_waitcnt vmcnt(5)
    buffer_load_dwordx4 v[64:67], v1, s[44:47], s69 offen offset:0 nt
    s_waitcnt vmcnt(5)
    buffer_load_dwordx4 v[68:71], v1, s[44:47], s69 offen offset:256 nt
    s_waitcnt vmcnt(5)
    buffer_load_dwordx4 v[72:75], v1, s[44:47], s69 offen offset:2048 nt
    s_waitcnt vmcnt(5)
    buffer_load_dwordx4 v[76:79], v1, s[44:47], s69 offen offset:2304 nt
    s_waitcnt vmcnt(5)
    buffer_load_dwordx4 v[80:83], v1, s[44:47], s70 offen offset:0 nt
    s_waitcnt vmcnt(5)
    buffer_load_dwordx4 v[84:87], v1, s[44:47], s70 offen offset:256 nt
    s_waitcnt vmcnt(5)
    buffer_load_dwordx4 v[88:91], v1, s[44:47], s70 offen offset:2048 nt
    s_waitcnt vmcnt(5)
    buffer_load_dwordx4 v[92:95], v1, s[44:47], s70 offen offset:2304 nt
    s_add_u32 s69, s69, 65536
    s_add_u32 s70, s70, 65536
    s_waitcnt vmcnt(5)
    buffer_load_dwordx4 v[96:99], v1, s[44:47], s69 offen offset:0 nt
    s_waitcnt vmcnt(5)
    buffer_load_dwordx4 v[100:103], v1, s[44:47], s69 offen offset:256 nt
    s_waitcnt vmcnt(5)
    buffer_load_dwordx4 v[104:107], v1, s[44:47], s69 offen offset:2048 nt
    s_waitcnt vmcnt(5)
    buffer_load_dwordx4 v[108:111], v1, s[44:47], s69 offen offset:2304 nt
    s_waitcnt vmcnt(5)
    buffer_load_dwordx4 v[112:115], v1, s[44:47], s70 offen offset:0 nt
    s_waitcnt vmcnt(5)
    buffer_load_dwordx4 v[116:119], v1, s[44:47], s70 offen offset:256 nt
    s_waitcnt vmcnt(5)
    buffer_load_dwordx4 v[120:123], v1, s[44:47], s70 offen offset:2048 nt
    s_waitcnt vmcnt(5)
    buffer_load_dwordx4 v[124:127], v1, s[44:47], s70 offen offset:2304 nt
    s_add_u32 s69, s69, 65536
    s_add_u32 s70, s70, 65536
    s_waitcnt vmcnt(5)
    buffer_load_dwordx4 v[128:131], v1, s[44:47], s69 offen offset:0 nt
    s_waitcnt vmcnt(5)
    buffer_load_dwordx4 v[132:135], v1, s[44:47], s69 offen offset:256 nt
    s_waitcnt vmcnt(5)
    buffer_load_dwordx4 v[136:139], v1, s[44:47], s69 offen offset:2048 nt
    s_waitcnt vmcnt(5)
    buffer_load_dwordx4 v[140:143], v1, s[44:47], s69 offen offset:2304 nt
    s_waitcnt vmcnt(5)
    buffer_load_dwordx4 v[144:147], v1, s[44:47], s70 offen offset:0 nt
    s_waitcnt vmcnt(5)
    buffer_load_dwordx4 v[148:151], v1, s[44:47], s70 offen offset:256 nt
    s_waitcnt vmcnt(5)
    buffer_load_dwordx4 v[152:155], v1, s[44:47], s70 offen offset:2048 nt
    s_waitcnt vmcnt(5)
    buffer_load_dwordx4 v[156:159], v1, s[44:47], s70 offen offset:2304 nt
    s_add_u32 s69, s69, 65536
    s_add_u32 s70, s70, 65536
    s_waitcnt vmcnt(5)
    buffer_load_dwordx4 v[160:163], v1, s[44:47], s69 offen offset:0 nt
    s_waitcnt vmcnt(5)
    buffer_load_dwordx4 v[164:167], v1, s[44:47], s69 offen offset:256 nt
    s_waitcnt vmcnt(5)
    buffer_load_dwordx4 v[168:171], v1, s[44:47], s69 offen offset:2048 nt
    s_waitcnt vmcnt(5)
    buffer_load_dwordx4 v[172:175], v1, s[44:47], s69 offen offset:2304 nt
    s_waitcnt vmcnt(5)
    buffer_load_dwordx4 v[176:179], v1, s[44:47], s70 offen offset:0 nt
    s_waitcnt vmcnt(5)
    buffer_load_dwordx4 v[180:183], v1, s[44:47], s70 offen offset:256 nt
    s_waitcnt vmcnt(5)
    buffer_load_dwordx4 v[184:187], v1, s[44:47], s70 offen offset:2048 nt
    s_waitcnt vmcnt(5)
    buffer_load_dwordx4 v[188:191], v1, s[44:47], s70 offen offset:2304 nt
    s_add_u32 s69, s69, 65536
    s_add_u32 s70, s70, 65536
    s_waitcnt vmcnt(5)
    buffer_load_dwordx4 v[192:195], v1, s[44:47], s69 offen offset:0 nt
    s_waitcnt vmcnt(5)
    buffer_load_dwordx4 v[196:199], v1, s[44:47], s69 offen offset:256 nt
    s_waitcnt vmcnt(5)
    buffer_load_dwordx4 v[200:203], v1, s[44:47], s69 offen offset:2048 nt
    s_waitcnt vmcnt(5)
    buffer_load_dwordx4 v[204:207], v1, s[44:47], s69 offen offset:2304 nt
    s_waitcnt vmcnt(5)
    buffer_load_dwordx4 v[208:211], v1, s[44:47], s70 offen offset:0 nt
    s_waitcnt vmcnt(5)
    buffer_load_dwordx4 v[212:215], v1, s[44:47], s70 offen offset:256 nt
    s_waitcnt vmcnt(5)
    buffer_load_dwordx4 v[216:219], v1, s[44:47], s70 offen offset:2048 nt
    s_waitcnt vmcnt(5)
    buffer_load_dwordx4 v[220:223], v1, s[44:47], s70 offen offset:2304 nt
    s_add_u32 s69, s69, 65536
    s_add_u32 s70, s70, 65536
    s_mov_b32 s80, 0x11111111
    s_mov_b32 s81, 0x11111111
    s_mov_b32 s82, 0x22222222
    s_mov_b32 s83, 0x22222222
    s_mov_b32 s84, 0x44444444
    s_mov_b32 s85, 0x44444444
    s_mov_b32 s86, 0x88888888
    s_mov_b32 s87, 0x88888888
    v_lshlrev_b32 v2, 4, v2
    s_waitcnt lgkmcnt(0)
    s_barrier
    ds_read_b128 v[8:11], v2 offset:45888
    ds_read_b128 v[12:15], v2 offset:46144
    v_bfe_u32 v3, v0, 2, 2
    s_waitcnt lgkmcnt(0)
    v_cmp_eq_u32 vcc, 0, v3
    s_nop 1
    v_cndmask_b32 v224, 0, v8, vcc
    v_cndmask_b32 v225, 0, v9, vcc
    v_cndmask_b32 v226, 0, v10, vcc
    v_cndmask_b32 v227, 0, v11, vcc
    v_cndmask_b32 v228, 0, v12, vcc
    v_cndmask_b32 v229, 0, v13, vcc
    v_cndmask_b32 v230, 0, v14, vcc
    v_cndmask_b32 v231, 0, v15, vcc
    v_cmp_eq_u32 vcc, 1, v3
    s_nop 1
    v_cndmask_b32 v232, 0, v8, vcc
    v_cndmask_b32 v233, 0, v9, vcc
    v_cndmask_b32 v234, 0, v10, vcc
    v_cndmask_b32 v235, 0, v11, vcc
    v_cndmask_b32 v236, 0, v12, vcc
    v_cndmask_b32 v237, 0, v13, vcc
    v_cndmask_b32 v238, 0, v14, vcc
    v_cndmask_b32 v239, 0, v15, vcc
    v_cmp_eq_u32 vcc, 2, v3
    s_nop 1
    v_cndmask_b32 v240, 0, v8, vcc
    v_cndmask_b32 v241, 0, v9, vcc
    v_cndmask_b32 v242, 0, v10, vcc
    v_cndmask_b32 v243, 0, v11, vcc
    v_cndmask_b32 v244, 0, v12, vcc
    v_cndmask_b32 v245, 0, v13, vcc
    v_cndmask_b32 v246, 0, v14, vcc
    v_cndmask_b32 v247, 0, v15, vcc
    v_cmp_eq_u32 vcc, 3, v3
    s_nop 1
    v_cndmask_b32 v248, 0, v8, vcc
    v_cndmask_b32 v249, 0, v9, vcc
    v_cndmask_b32 v250, 0, v10, vcc
    v_cndmask_b32 v251, 0, v11, vcc
    v_cndmask_b32 v252, 0, v12, vcc
    v_cndmask_b32 v253, 0, v13, vcc
    v_cndmask_b32 v254, 0, v14, vcc
    v_cndmask_b32 v255, 0, v15, vcc
    s_waitcnt vmcnt(6)
    s_mov_b64 vcc, 0
    v_mfma_f32_16x16x32_bf16 v[8:11], v[32:35], v[224:227], 0
    v_mfma_f32_16x16x32_bf16 v[8:11], v[36:39], v[228:231], v[8:11]
    s_waitcnt vmcnt(5)
    s_cbranch_vccnz L_w_1
    s_waitcnt vmcnt(4)
L_w_1:
    buffer_load_dwordx4 v[32:35], v1, s[44:47], s69 offen offset:0 nt
    v_mfma_f32_16x16x32_bf16 v[8:11], v[40:43], v[232:235], v[8:11]
    v_mfma_f32_16x16x32_bf16 v[8:11], v[44:47], v[236:239], v[8:11]
    s_waitcnt vmcnt(5)
    s_cbranch_vccnz L_w_2
    s_waitcnt vmcnt(4)
L_w_2:
    buffer_load_dwordx4 v[36:39], v1, s[44:47], s69 offen offset:256 nt
    s_add_u32 s76, s76, 1
    s_waitcnt lgkmcnt(0)
    v_readfirstlane_b32 s12, v28
    v_mov_b32 v30, s76
    ds_write_b32 v27, v30 offset:46400
    ds_read_b32 v28, v29 offset:46416
    s_cmp_lt_u32 s76, s12
    s_cselect_b64 vcc, -1, 0
    v_mfma_f32_16x16x32_bf16 v[8:11], v[48:51], v[240:243], v[8:11]
    v_mfma_f32_16x16x32_bf16 v[8:11], v[52:55], v[244:247], v[8:11]
    s_waitcnt vmcnt(5)
    s_cbranch_vccnz L_w_3
    s_waitcnt vmcnt(4)
L_w_3:
    buffer_load_dwordx4 v[40:43], v1, s[44:47], s69 offen offset:2048 nt
    v_mfma_f32_16x16x32_bf16 v[8:11], v[56:59], v[248:251], v[8:11]
    v_mfma_f32_16x16x32_bf16 v[8:11], v[60:63], v[252:255], v[8:11]
    s_waitcnt vmcnt(5)
    s_cbranch_vccnz L_w_4
    s_waitcnt vmcnt(4)
L_w_4:
    buffer_load_dwordx4 v[44:47], v1, s[44:47], s69 offen offset:2304 nt
    s_nop 5
    v_mov_b32_dpp v24, v8 quad_perm:[0,0,0,0] row_mask:0xf bank_mask:0xf
    v_mov_b32_dpp v25, v10 quad_perm:[2,2,2,2] row_mask:0xf bank_mask:0xf
    s_nop 0
    v_add_f32_dpp v24, v9, v24 quad_perm:[1,1,1,1] row_mask:0xf bank_mask:0xf
    v_add_f32_dpp v25, v11, v25 quad_perm:[3,3,3,3] row_mask:0xf bank_mask:0xf
    v_add_f32 v26, v24, v25
    v_mfma_f32_16x16x32_bf16 v[12:15], v[64:67], v[224:227], 0
    v_mfma_f32_16x16x32_bf16 v[12:15], v[68:71], v[228:231], v[12:15]
    s_waitcnt vmcnt(5)
    s_cbranch_vccnz L_w_5
    s_waitcnt vmcnt(4)
L_w_5:
    buffer_load_dwordx4 v[48:51], v1, s[44:47], s70 offen offset:0 nt
    v_mfma_f32_16x16x32_bf16 v[12:15], v[72:75], v[232:235], v[12:15]
    v_mfma_f32_16x16x32_bf16 v[12:15], v[76:79], v[236:239], v[12:15]
    s_waitcnt vmcnt(5)
    s_cbranch_vccnz L_w_6
    s_waitcnt vmcnt(4)
L_w_6:
    buffer_load_dwordx4 v[52:55], v1, s[44:47], s70 offen offset:256 nt
    s_add_u32 s76, s76, 1
    s_waitcnt lgkmcnt(0)
    v_readfirstlane_b32 s12, v28
    v_mov_b32 v30, s76
    ds_write_b32 v27, v30 offset:46400
    ds_read_b32 v28, v29 offset:46416
    s_cmp_lt_u32 s76, s12
    s_cselect_b64 vcc, -1, 0
    v_mfma_f32_16x16x32_bf16 v[12:15], v[80:83], v[240:243], v[12:15]
    v_mfma_f32_16x16x32_bf16 v[12:15], v[84:87], v[244:247], v[12:15]
    s_waitcnt vmcnt(5)
    s_cbranch_vccnz L_w_7
    s_waitcnt vmcnt(4)
L_w_7:
    buffer_load_dwordx4 v[56:59], v1, s[44:47], s70 offen offset:2048 nt
    v_mfma_f32_16x16x32_bf16 v[12:15], v[88:91], v[248:251], v[12:15]
    v_mfma_f32_16x16x32_bf16 v[12:15], v[92:95], v[252:255], v[12:15]
    s_waitcnt vmcnt(5)
    s_cbranch_vccnz L_w_8
    s_waitcnt vmcnt(4)
L_w_8:
    buffer_load_dwordx4 v[60:63], v1, s[44:47], s70 offen offset:2304 nt
    s_add_u32 s69, s69, 65536
    s_add_u32 s70, s70, 65536
    s_nop 5
    v_mov_b32_dpp v24, v12 quad_perm:[0,0,0,0] row_mask:0xf bank_mask:0xf
    v_mov_b32_dpp v25, v14 quad_perm:[2,2,2,2] row_mask:0xf bank_mask:0xf
    s_nop 0
    v_add_f32_dpp v24, v13, v24 quad_perm:[1,1,1,1] row_mask:0xf bank_mask:0xf
    v_add_f32_dpp v25, v15, v25 quad_perm:[3,3,3,3] row_mask:0xf bank_mask:0xf
    v_add_f32 v24, v24, v25
    v_cndmask_b32 v26, v26, v24, s[82:83]
    v_mfma_f32_16x16x32_bf16 v[8:11], v[96:99], v[224:227], 0
    v_mfma_f32_16x16x32_bf16 v[8:11], v[100:103], v[228:231], v[8:11]
    s_waitcnt vmcnt(5)
    s_cbranch_vccnz L_w_9
    s_waitcnt vmcnt(4)
L_w_9:
    buffer_load_dwordx4 v[64:67], v1, s[44:47], s69 offen offset:0 nt
    v_mfma_f32_16x16x32_bf16 v[8:11], v[104:107], v[232:235], v[8:11]
    v_mfma_f32_16x16x32_bf16 v[8:11], v[108:111], v[236:239], v[8:11]
    s_waitcnt vmcnt(5)
    s_cbranch_vccnz L_w_10
    s_waitcnt vmcnt(4)
L_w_10:
    buffer_load_dwordx4 v[68:71], v1, s[44:47], s69 offen offset:256 nt
    s_add_u32 s76, s76, 1
    s_waitcnt lgkmcnt(0)
    v_readfirstlane_b32 s12, v28
    v_mov_b32 v30, s76
    ds_write_b32 v27, v30 offset:46400
    ds_read_b32 v28, v29 offset:46416
    s_cmp_lt_u32 s76, s12
    s_cselect_b64 vcc, -1, 0
    v_mfma_f32_16x16x32_bf16 v[8:11], v[112:115], v[240:243], v[8:11]
    v_mfma_f32_16x16x32_bf16 v[8:11], v[116:119], v[244:247], v[8:11]
    s_waitcnt vmcnt(5)
    s_cbranch_vccnz L_w_11
    s_waitcnt vmcnt(4)
L_w_11:
    buffer_load_dwordx4 v[72:75], v1, s[44:47], s69 offen offset:2048 nt
    v_mfma_f32_16x16x32_bf16 v[8:11], v[120:123], v[248:251], v[8:11]
    v_mfma_f32_16x16x32_bf16 v[8:11], v[124:127], v[252:255], v[8:11]
    s_waitcnt vmcnt(5)
    s_cbranch_vccnz L_w_12
    s_waitcnt vmcnt(4)
L_w_12:
    buffer_load_dwordx4 v[76:79], v1, s[44:47], s69 offen offset:2304 nt
    s_nop 5
    v_mov_b32_dpp v24, v8 quad_perm:[0,0,0,0] row_mask:0xf bank_mask:0xf
    v_mov_b32_dpp v25, v10 quad_perm:[2,2,2,2] row_mask:0xf bank_mask:0xf
    s_nop 0
    v_add_f32_dpp v24, v9, v24 quad_perm:[1,1,1,1] row_mask:0xf bank_mask:0xf
    v_add_f32_dpp v25, v11, v25 quad_perm:[3,3,3,3] row_mask:0xf bank_mask:0xf
    v_add_f32 v24, v24, v25
    v_cndmask_b32 v26, v26, v24, s[84:85]
    v_mfma_f32_16x16x32_bf16 v[12:15], v[128:131], v[224:227], 0
    v_mfma_f32_16x16x32_bf16 v[12:15], v[132:135], v[228:231], v[12:15]
    s_waitcnt vmcnt(5)
    s_cbranch_vccnz L_w_13
    s_waitcnt vmcnt(4)
L_w_13:
    buffer_load_dwordx4 v[80:83], v1, s[44:47], s70 offen offset:0 nt
    v_mfma_f32_16x16x32_bf16 v[12:15], v[136:139], v[232:235], v[12:15]
    v_mfma_f32_16x16x32_bf16 v[12:15], v[140:143], v[236:239], v[12:15]
    s_waitcnt vmcnt(5)
    s_cbranch_vccnz L_w_14
    s_waitcnt vmcnt(4)
L_w_14:
    buffer_load_dwordx4 v[84:87], v1, s[44:47], s70 offen offset:256 nt
    s_add_u32 s76, s76, 1
    s_waitcnt lgkmcnt(0)
    v_readfirstlane_b32 s12, v28
    v_mov_b32 v30, s76
    ds_write_b32 v27, v30 offset:46400
    ds_read_b32 v28, v29 offset:46416
    s_cmp_lt_u32 s76, s12
    s_cselect_b64 vcc, -1, 0
    v_mfma_f32_16x16x32_bf16 v[12:15], v[144:147], v[240:243], v[12:15]
    v_mfma_f32_16x16x32_bf16 v[12:15], v[148:151], v[244:247], v[12:15]
    s_waitcnt vmcnt(5)
    s_cbranch_vccnz L_w_15
    s_waitcnt vmcnt(4)
L_w_15:
    buffer_load_dwordx4 v[88:91], v1, s[44:47], s70 offen offset:2048 nt
    v_mfma_f32_16x16x32_bf16 v[12:15], v[152:155], v[248:251], v[12:15]
    v_mfma_f32_16x16x32_bf16 v[12:15], v[156:159], v[252:255], v[12:15]
    s_waitcnt vmcnt(5)
    s_cbranch_vccnz L_w_16
    s_waitcnt vmcnt(4)
L_w_16:
    buffer_load_dwordx4 v[92:95], v1, s[44:47], s70 offen offset:2304 nt
    s_add_u32 s69, s69, 65536
    s_add_u32 s70, s70, 65536
    s_nop 5
    v_mov_b32_dpp v24, v12 quad_perm:[0,0,0,0] row_mask:0xf bank_mask:0xf
    v_mov_b32_dpp v25, v14 quad_perm:[2,2,2,2] row_mask:0xf bank_mask:0xf
    s_nop 0
    v_add_f32_dpp v24, v13, v24 quad_perm:[1,1,1,1] row_mask:0xf bank_mask:0xf
    v_add_f32_dpp v25, v15, v25 quad_perm:[3,3,3,3] row_mask:0xf bank_mask:0xf
    v_add_f32 v24, v24, v25
    v_cndmask_b32 v26, v26, v24, s[86:87]
    v_mov_b32 v16, v17
    v_mov_b32 v17, v18
    v_mov_b32 v18, v19
    v_mov_b32 v19, v20
    v_mov_b32 v20, v21
    v_mov_b32 v21, v22
    v_mov_b32 v22, v23
    v_mov_b32 v23, v26
    v_mfma_f32_16x16x32_bf16 v[8:11], v[160:163], v[224:227], 0
    s_waitcnt vmcnt(5)
    s_cbranch_vccnz L_w_17
    s_waitcnt vmcnt(4)
L_w_17:
    buffer_load_dwordx4 v[96:99], v1, s[44:47], s69 offen offset:0 nt
    v_mfma_f32_16x16x32_bf16 v[8:11], v[164:167], v[228:231], v[8:11]
    s_waitcnt vmcnt(5)
    s_cbranch_vccnz L_w_18
    s_waitcnt vmcnt(4)
L_w_18:
    buffer_load_dwordx4 v[100:103], v1, s[44:47], s69 offen offset:256 nt
    s_add_u32 s76, s76, 1
    s_waitcnt lgkmcnt(0)
    v_readfirstlane_b32 s12, v28
    v_mov_b32 v30, s76
    ds_write_b32 v27, v30 offset:46400
    ds_read_b32 v28, v29 offset:46416
    s_cmp_lt_u32 s76, s12
    s_cselect_b64 vcc, -1, 0
    v_mfma_f32_16x16x32_bf16 v[8:11], v[168:171], v[232:235], v[8:11]
    s_waitcnt vmcnt(5)
    s_cbranch_vccnz L_w_19
    s_waitcnt vmcnt(4)
L_w_19:
    buffer_load_dwordx4 v[104:107], v1, s[44:47], s69 offen offset:2048 nt
    v_mfma_f32_16x16x32_bf16 v[8:11], v[172:175], v[236:239], v[8:11]
    s_waitcnt vmcnt(5)
    s_cbranch_vccnz L_w_20
    s_waitcnt vmcnt(4)
L_w_20:
    buffer_load_dwordx4 v[108:111], v1, s[44:47], s69 offen offset:2304 nt
    v_mfma_f32_16x16x32_bf16 v[8:11], v[176:179], v[240:243], v[8:11]
    s_waitcnt vmcnt(5)
    s_cbranch_vccnz L_w_21
    s_waitcnt vmcnt(4)
L_w_21:
    buffer_load_dwordx4 v[112:115], v1, s[44:47], s70 offen offset:0 nt
    v_mfma_f32_16x16x32_bf16 v[8:11], v[180:183], v[244:247], v[8:11]
    s_waitcnt vmcnt(5)
    s_cbranch_vccnz L_w_22
    s_waitcnt vmcnt(4)
L_w_22:
    buffer_load_dwordx4 v[116:119], v1, s[44:47], s70 offen offset:256 nt
    s_add_u32 s76, s76, 1
    s_waitcnt lgkmcnt(0)
    v_readfirstlane_b32 s12, v28
    v_mov_b32 v30, s76
    ds_write_b32 v27, v30 offset:46400
    ds_read_b32 v28, v29 offset:46416
    s_cmp_lt_u32 s76, s12
    s_cselect_b64 vcc, -1, 0
    v_mfma_f32_16x16x32_bf16 v[8:11], v[184:187], v[248:251], v[8:11]
    s_waitcnt vmcnt(5)
    s_cbranch_vccnz L_w_23
    s_waitcnt vmcnt(4)
L_w_23:
    buffer_load_dwordx4 v[120:123], v1, s[44:47], s70 offen offset:2048 nt
    v_mfma_f32_16x16x32_bf16 v[8:11], v[188:191], v[252:255], v[8:11]
    s_waitcnt vmcnt(5)
    s_cbranch_vccnz L_w_24
    s_waitcnt vmcnt(4)
L_w_24:
    buffer_load_dwordx4 v[124:127], v1, s[44:47], s70 offen offset:2304 nt
    s_add_u32 s69, s69, 65536
    s_add_u32 s70, s70, 65536
    s_nop 5
    v_mov_b32_dpp v24, v8 quad_perm:[0,0,0,0] row_mask:0xf bank_mask:0xf
    v_mov_b32_dpp v25, v10 quad_perm:[2,2,2,2] row_mask:0xf bank_mask:0xf
    s_nop 0
    v_add_f32_dpp v24, v9, v24 quad_perm:[1,1,1,1] row_mask:0xf bank_mask:0xf
    v_add_f32_dpp v25, v11, v25 quad_perm:[3,3,3,3] row_mask:0xf bank_mask:0xf
    v_add_f32 v26, v24, v25
    v_mfma_f32_16x16x32_bf16 v[12:15], v[192:195], v[224:227], 0
    s_waitcnt vmcnt(5)
    s_cbranch_vccnz L_w_25
    s_waitcnt vmcnt(4)
L_w_25:
    buffer_load_dwordx4 v[128:131], v1, s[44:47], s69 offen offset:0 nt
    v_mfma_f32_16x16x32_bf16 v[12:15], v[196:199], v[228:231], v[12:15]
    s_waitcnt vmcnt(5)
    s_cbranch_vccnz L_w_26
    s_waitcnt vmcnt(4)
L_w_26:
    buffer_load_dwordx4 v[132:135], v1, s[44:47], s69 offen offset:256 nt
    s_add_u32 s76, s76, 1
    s_waitcnt lgkmcnt(0)
    v_readfirstlane_b32 s12, v28
    v_mov_b32 v30, s76
    ds_write_b32 v27, v30 offset:46400
    ds_read_b32 v28, v29 offset:46416
    s_cmp_lt_u32 s76, s12
    s_cselect_b64 vcc, -1, 0
    v_mfma_f32_16x16x32_bf16 v[12:15], v[200:203], v[232:235], v[12:15]
    s_waitcnt vmcnt(5)
    s_cbranch_vccnz L_w_27
    s_waitcnt vmcnt(4)
L_w_27:
    buffer_load_dwordx4 v[136:139], v1, s[44:47], s69 offen offset:2048 nt
    v_mfma_f32_16x16x32_bf16 v[12:15], v[204:207], v[236:239], v[12:15]
    s_waitcnt vmcnt(5)
    s_cbranch_vccnz L_w_28
    s_waitcnt vmcnt(4)
L_w_28:
    buffer_load_dwordx4 v[140:143], v1, s[44:47], s69 offen offset:2304 nt
    v_mfma_f32_16x16x32_bf16 v[12:15], v[208:211], v[240:243], v[12:15]
    s_waitcnt vmcnt(5)
    s_cbranch_vccnz L_w_29
    s_waitcnt vmcnt(4)
L_w_29:
    buffer_load_dwordx4 v[144:147], v1, s[44:47], s70 offen offset:0 nt
    v_mfma_f32_16x16x32_bf16 v[12:15], v[212:215], v[244:247], v[12:15]
    s_waitcnt vmcnt(5)
    s_cbranch_vccnz L_w_30
    s_waitcnt vmcnt(4)
L_w_30:
    buffer_load_dwordx4 v[148:151], v1, s[44:47], s70 offen offset:256 nt
    s_add_u32 s76, s76, 1
    s_waitcnt lgkmcnt(0)
    v_readfirstlane_b32 s12, v28
    v_mov_b32 v30, s76
    ds_write_b32 v27, v30 offset:46400
    ds_read_b32 v28, v29 offset:46416
    s_cmp_lt_u32 s76, s12
    s_cselect_b64 vcc, -1, 0
    v_mfma_f32_16x16x32_bf16 v[12:15], v[216:219], v[248:251], v[12:15]
    s_waitcnt vmcnt(5)
    s_cbranch_vccnz L_w_31
    s_waitcnt vmcnt(4)
L_w_31:
    buffer_load_dwordx4 v[152:155], v1, s[44:47], s70 offen offset:2048 nt
    v_mfma_f32_16x16x32_bf16 v[12:15], v[220:223], v[252:255], v[12:15]
    s_waitcnt vmcnt(5)
    s_cbranch_vccnz L_w_32
    s_waitcnt vmcnt(4)
L_w_32:
    buffer_load_dwordx4 v[156:159], v1, s[44:47], s70 offen offset:2304 nt
    s_add_u32 s69, s69, 65536
    s_add_u32 s70, s70, 65536
    s_nop 5
    v_mov_b32_dpp v24, v12 quad_perm:[0,0,0,0] row_mask:0xf bank_mask:0xf
    v_mov_b32_dpp v25, v14 quad_perm:[2,2,2,2] row_mask:0xf bank_mask:0xf
    s_nop 0
    v_add_f32_dpp v24, v13, v24 quad_perm:[1,1,1,1] row_mask:0xf bank_mask:0xf
    v_add_f32_dpp v25, v15, v25 quad_perm:[3,3,3,3] row_mask:0xf bank_mask:0xf
    v_add_f32 v24, v24, v25
    v_cndmask_b32 v26, v26, v24, s[82:83]
    v_mfma_f32_16x16x32_bf16 v[8:11], v[32:35], v[224:227], 0
    s_waitcnt vmcnt(5)
    s_cbranch_vccnz L_w_33
    s_waitcnt vmcnt(4)
L_w_33:
    buffer_load_dwordx4 v[32:35], v1, s[44:47], s69 offen offset:0 nt
    v_mfma_f32_16x16x32_bf16 v[8:11], v[36:39], v[228:231], v[8:11]
    s_waitcnt vmcnt(5)
    s_cbranch_vccnz L_w_34
    s_waitcnt vmcnt(4)
L_w_34:
    buffer_load_dwordx4 v[36:39], v1, s[44:47], s69 offen offset:256 nt
    s_add_u32 s76, s76, 1
    s_waitcnt lgkmcnt(0)
    v_readfirstlane_b32 s12, v28
    v_mov_b32 v30, s76
    ds_write_b32 v27, v30 offset:46400
    ds_read_b32 v28, v29 offset:46416
    s_cmp_lt_u32 s76, s12
    s_cselect_b64 vcc, -1, 0
    v_mfma_f32_16x16x32_bf16 v[8:11], v[40:43], v[232:235], v[8:11]
    s_waitcnt vmcnt(5)
    s_cbranch_vccnz L_w_35
    s_waitcnt vmcnt(4)
L_w_35:
    buffer_load_dwordx4 v[40:43], v1, s[44:47], s69 offen offset:2048 nt
    v_mfma_f32_16x16x32_bf16 v[8:11], v[44:47], v[236:239], v[8:11]
    s_waitcnt vmcnt(5)
    s_cbranch_vccnz L_w_36
    s_waitcnt vmcnt(4)
L_w_36:
    buffer_load_dwordx4 v[44:47], v1, s[44:47], s69 offen offset:2304 nt
    v_mfma_f32_16x16x32_bf16 v[8:11], v[48:51], v[240:243], v[8:11]
    s_waitcnt vmcnt(5)
    s_cbranch_vccnz L_w_37
    s_waitcnt vmcnt(4)
L_w_37:
    buffer_load_dwordx4 v[48:51], v1, s[44:47], s70 offen offset:0 nt
    v_mfma_f32_16x16x32_bf16 v[8:11], v[52:55], v[244:247], v[8:11]
    s_waitcnt vmcnt(5)
    s_cbranch_vccnz L_w_38
    s_waitcnt vmcnt(4)
L_w_38:
    buffer_load_dwordx4 v[52:55], v1, s[44:47], s70 offen offset:256 nt
    s_add_u32 s76, s76, 1
    s_waitcnt lgkmcnt(0)
    v_readfirstlane_b32 s12, v28
    v_mov_b32 v30, s76
    ds_write_b32 v27, v30 offset:46400
    ds_read_b32 v28, v29 offset:46416
    s_cmp_lt_u32 s76, s12
    s_cselect_b64 vcc, -1, 0
    v_mfma_f32_16x16x32_bf16 v[8:11], v[56:59], v[248:251], v[8:11]
    s_waitcnt vmcnt(5)
    s_cbranch_vccnz L_w_39
    s_waitcnt vmcnt(4)
L_w_39:
    buffer_load_dwordx4 v[56:59], v1, s[44:47], s70 offen offset:2048 nt
    v_mfma_f32_16x16x32_bf16 v[8:11], v[60:63], v[252:255], v[8:11]
    s_waitcnt vmcnt(5)
    s_cbranch_vccnz L_w_40
    s_waitcnt vmcnt(4)
L_w_40:
    buffer_load_dwordx4 v[60:63], v1, s[44:47], s70 offen offset:2304 nt
    s_add_u32 s69, s69, 65536
    s_add_u32 s70, s70, 65536
    s_nop 5
    v_mov_b32_dpp v24, v8 quad_perm:[0,0,0,0] row_mask:0xf bank_mask:0xf
    v_mov_b32_dpp v25, v10 quad_perm:[2,2,2,2] row_mask:0xf bank_mask:0xf
    s_nop 0
    v_add_f32_dpp v24, v9, v24 quad_perm:[1,1,1,1] row_mask:0xf bank_mask:0xf
    v_add_f32_dpp v25, v11, v25 quad_perm:[3,3,3,3] row_mask:0xf bank_mask:0xf
    v_add_f32 v24, v24, v25
    v_cndmask_b32 v26, v26, v24, s[84:85]
    v_mfma_f32_16x16x32_bf16 v[12:15], v[64:67], v[224:227], 0
    s_waitcnt vmcnt(5)
    s_cbranch_vccnz L_w_41
    s_waitcnt vmcnt(4)
L_w_41:
    buffer_load_dwordx4 v[64:67], v1, s[44:47], s69 offen offset:0 nt
    v_mfma_f32_16x16x32_bf16 v[12:15], v[68:71], v[228:231], v[12:15]
    s_waitcnt vmcnt(5)
    s_cbranch_vccnz L_w_42
    s_waitcnt vmcnt(4)
L_w_42:
    buffer_load_dwordx4 v[68:71], v1, s[44:47], s69 offen offset:256 nt
    s_add_u32 s76, s76, 1
    s_waitcnt lgkmcnt(0)
    v_readfirstlane_b32 s12, v28
    v_mov_b32 v30, s76
    ds_write_b32 v27, v30 offset:46400
    ds_read_b32 v28, v29 offset:46416
    s_cmp_lt_u32 s76, s12
    s_cselect_b64 vcc, -1, 0
    v_mfma_f32_16x16x32_bf16 v[12:15], v[72:75], v[232:235], v[12:15]
    s_waitcnt vmcnt(5)
    s_cbranch_vccnz L_w_43
    s_waitcnt vmcnt(4)
L_w_43:
    buffer_load_dwordx4 v[72:75], v1, s[44:47], s69 offen offset:2048 nt
    v_mfma_f32_16x16x32_bf16 v[12:15], v[76:79], v[236:239], v[12:15]
    s_waitcnt vmcnt(5)
    s_cbranch_vccnz L_w_44
    s_waitcnt vmcnt(4)
L_w_44:
    buffer_load_dwordx4 v[76:79], v1, s[44:47], s69 offen offset:2304 nt
    v_mfma_f32_16x16x32_bf16 v[12:15], v[80:83], v[240:243], v[12:15]
    s_waitcnt vmcnt(5)
    s_cbranch_vccnz L_w_45
    s_waitcnt vmcnt(4)
L_w_45:
    buffer_load_dwordx4 v[80:83], v1, s[44:47], s70 offen offset:0 nt
    v_mfma_f32_16x16x32_bf16 v[12:15], v[84:87], v[244:247], v[12:15]
    s_waitcnt vmcnt(5)
    s_cbranch_vccnz L_w_46
    s_waitcnt vmcnt(4)
L_w_46:
    buffer_load_dwordx4 v[84:87], v1, s[44:47], s70 offen offset:256 nt
    s_add_u32 s76, s76, 1
    s_waitcnt lgkmcnt(0)
    v_readfirstlane_b32 s12, v28
    v_mov_b32 v30, s76
    ds_write_b32 v27, v30 offset:46400
    ds_read_b32 v28, v29 offset:46416
    s_cmp_lt_u32 s76, s12
    s_cselect_b64 vcc, -1, 0
    v_mfma_f32_16x16x32_bf16 v[12:15], v[88:91], v[248:251], v[12:15]
    s_waitcnt vmcnt(5)
    s_cbranch_vccnz L_w_47
    s_waitcnt vmcnt(4)
L_w_47:
    buffer_load_dwordx4 v[88:91], v1, s[44:47], s70 offen offset:2048 nt
    v_mfma_f32_16x16x32_bf16 v[12:15], v[92:95], v[252:255], v[12:15]
    s_waitcnt vmcnt(5)
    s_cbranch_vccnz L_w_48
    s_waitcnt vmcnt(4)
L_w_48:
    buffer_load_dwordx4 v[92:95], v1, s[44:47], s70 offen offset:2304 nt
    s_add_u32 s69, s69, 65536
    s_add_u32 s70, s70, 65536
    s_nop 5
    v_mov_b32_dpp v24, v12 quad_perm:[0,0,0,0] row_mask:0xf bank_mask:0xf
    v_mov_b32_dpp v25, v14 quad_perm:[2,2,2,2] row_mask:0xf bank_mask:0xf
    s_nop 0
    v_add_f32_dpp v24, v13, v24 quad_perm:[1,1,1,1] row_mask:0xf bank_mask:0xf
    v_add_f32_dpp v25, v15, v25 quad_perm:[3,3,3,3] row_mask:0xf bank_mask:0xf
    v_add_f32 v24, v24, v25
    v_cndmask_b32 v26, v26, v24, s[86:87]
    v_mov_b32 v16, v17
    v_mov_b32 v17, v18
    v_mov_b32 v18, v19
    v_mov_b32 v19, v20
    v_mov_b32 v20, v21
    v_mov_b32 v21, v22
    v_mov_b32 v22, v23
    v_mov_b32 v23, v26
    s_mov_b32 s71, 5
L_kloop:
    v_mfma_f32_16x16x32_bf16 v[8:11], v[96:99], v[224:227], 0
    s_waitcnt vmcnt(5)
    s_cbranch_vccnz L_w_49
    s_waitcnt vmcnt(4)
L_w_49:
    buffer_load_dwordx4 v[96:99], v1, s[44:47], s69 offen offset:0 nt
    v_mfma_f32_16x16x32_bf16 v[8:11], v[100:103], v[228:231], v[8:11]
    s_waitcnt vmcnt(5)
    s_cbranch_vccnz L_w_50
    s_waitcnt vmcnt(4)
L_w_50:
    buffer_load_dwordx4 v[100:103], v1, s[44:47], s69 offen offset:256 nt
    s_add_u32 s76, s76, 1
    s_waitcnt lgkmcnt(0)
    v_readfirstlane_b32 s12, v28
    v_mov_b32 v30, s76
    ds_write_b32 v27, v30 offset:46400
    ds_read_b32 v28, v29 offset:46416
    s_cmp_lt_u32 s76, s12
    s_cselect_b64 vcc, -1, 0
    v_mfma_f32_16x16x32_bf16 v[8:11], v[104:107], v[232:235], v[8:11]
    s_waitcnt vmcnt(5)
    s_cbranch_vccnz L_w_51
    s_waitcnt vmcnt(4)
L_w_51:
    buffer_load_dwordx4 v[104:107], v1, s[44:47], s69 offen offset:2048 nt
    v_mfma_f32_16x16x32_bf16 v[8:11], v[108:111], v[236:239], v[8:11]
    s_waitcnt vmcnt(5)
    s_cbranch_vccnz L_w_52
    s_waitcnt vmcnt(4)
L_w_52:
    buffer_load_dwordx4 v[108:111], v1, s[44:47], s69 offen offset:2304 nt
    v_mfma_f32_16x16x32_bf16 v[8:11], v[112:115], v[240:243], v[8:11]
    s_waitcnt vmcnt(5)
    s_cbranch_vccnz L_w_53
    s_waitcnt vmcnt(4)
L_w_53:
    buffer_load_dwordx4 v[112:115], v1, s[44:47], s70 offen offset:0 nt
    v_mfma_f32_16x16x32_bf16 v[8:11], v[116:119], v[244:247], v[8:11]
    s_waitcnt vmcnt(5)
    s_cbranch_vccnz L_w_54
    s_waitcnt vmcnt(4)
L_w_54:
    buffer_load_dwordx4 v[116:119], v1, s[44:47], s70 offen offset:256 nt
    s_add_u32 s76, s76, 1
    s_waitcnt lgkmcnt(0)
    v_readfirstlane_b32 s12, v28
    v_mov_b32 v30, s76
    ds_write_b32 v27, v30 offset:46400
    ds_read_b32 v28, v29 offset:46416
    s_cmp_lt_u32 s76, s12
    s_cselect_b64 vcc, -1, 0
    v_mfma_f32_16x16x32_bf16 v[8:11], v[120:123], v[248:251], v[8:11]
    s_waitcnt vmcnt(5)
    s_cbranch_vccnz L_w_55
    s_waitcnt vmcnt(4)
L_w_55:
    buffer_load_dwordx4 v[120:123], v1, s[44:47], s70 offen offset:2048 nt
    v_mfma_f32_16x16x32_bf16 v[8:11], v[124:127], v[252:255], v[8:11]
    s_waitcnt vmcnt(5)
    s_cbranch_vccnz L_w_56
    s_waitcnt vmcnt(4)
L_w_56:
    buffer_load_dwordx4 v[124:127], v1, s[44:47], s70 offen offset:2304 nt
    s_add_u32 s69, s69, 65536
    s_add_u32 s70, s70, 65536
    s_nop 3
    v_mov_b32_dpp v24, v8 quad_perm:[0,0,0,0] row_mask:0xf bank_mask:0xf
    v_mov_b32_dpp v25, v10 quad_perm:[2,2,2,2] row_mask:0xf bank_mask:0xf
    s_nop 0
    v_add_f32_dpp v24, v9, v24 quad_perm:[1,1,1,1] row_mask:0xf bank_mask:0xf
    v_add_f32_dpp v25, v11, v25 quad_perm:[3,3,3,3] row_mask:0xf bank_mask:0xf
    v_add_f32 v26, v24, v25
    v_mfma_f32_16x16x32_bf16 v[12:15], v[128:131], v[224:227], 0
    s_waitcnt vmcnt(5)
    s_cbranch_vccnz L_w_57
    s_waitcnt vmcnt(4)
L_w_57:
    buffer_load_dwordx4 v[128:131], v1, s[44:47], s69 offen offset:0 nt
    v_mfma_f32_16x16x32_bf16 v[12:15], v[132:135], v[228:231], v[12:15]
    s_waitcnt vmcnt(5)
    s_cbranch_vccnz L_w_58
    s_waitcnt vmcnt(4)
L_w_58:
    buffer_load_dwordx4 v[132:135], v1, s[44:47], s69 offen offset:256 nt
    s_add_u32 s76, s76, 1
    s_waitcnt lgkmcnt(0)
    v_readfirstlane_b32 s12, v28
    v_mov_b32 v30, s76
    ds_write_b32 v27, v30 offset:46400
    ds_read_b32 v28, v29 offset:46416
    s_cmp_lt_u32 s76, s12
    s_cselect_b64 vcc, -1, 0
    v_mfma_f32_16x16x32_bf16 v[12:15], v[136:139], v[232:235], v[12:15]
    s_waitcnt vmcnt(5)
    s_cbranch_vccnz L_w_59
    s_waitcnt vmcnt(4)
L_w_59:
    buffer_load_dwordx4 v[136:139], v1, s[44:47], s69 offen offset:2048 nt
    v_mfma_f32_16x16x32_bf16 v[12:15], v[140:143], v[236:239], v[12:15]
    s_waitcnt vmcnt(5)
    s_cbranch_vccnz L_w_60
    s_waitcnt vmcnt(4)
L_w_60:
    buffer_load_dwordx4 v[140:143], v1, s[44:47], s69 offen offset:2304 nt
    v_mfma_f32_16x16x32_bf16 v[12:15], v[144:147], v[240:243], v[12:15]
    s_waitcnt vmcnt(5)
    s_cbranch_vccnz L_w_61
    s_waitcnt vmcnt(4)
L_w_61:
    buffer_load_dwordx4 v[144:147], v1, s[44:47], s70 offen offset:0 nt
    v_mfma_f32_16x16x32_bf16 v[12:15], v[148:151], v[244:247], v[12:15]
    s_waitcnt vmcnt(5)
    s_cbranch_vccnz L_w_62
    s_waitcnt vmcnt(4)
L_w_62:
    buffer_load_dwordx4 v[148:151], v1, s[44:47], s70 offen offset:256 nt
    s_add_u32 s76, s76, 1
    s_waitcnt lgkmcnt(0)
    v_readfirstlane_b32 s12, v28
    v_mov_b32 v30, s76
    ds_write_b32 v27, v30 offset:46400
    ds_read_b32 v28, v29 offset:46416
    s_cmp_lt_u32 s76, s12
    s_cselect_b64 vcc, -1, 0
    v_mfma_f32_16x16x32_bf16 v[12:15], v[152:155], v[248:251], v[12:15]
    s_waitcnt vmcnt(5)
    s_cbranch_vccnz L_w_63
    s_waitcnt vmcnt(4)
L_w_63:
    buffer_load_dwordx4 v[152:155], v1, s[44:47], s70 offen offset:2048 nt
    v_mfma_f32_16x16x32_bf16 v[12:15], v[156:159], v[252:255], v[12:15]
    s_waitcnt vmcnt(5)
    s_cbranch_vccnz L_w_64
    s_waitcnt vmcnt(4)
L_w_64:
    buffer_load_dwordx4 v[156:159], v1, s[44:47], s70 offen offset:2304 nt
    s_add_u32 s69, s69, 65536
    s_add_u32 s70, s70, 65536
    s_nop 3
    v_mov_b32_dpp v24, v12 quad_perm:[0,0,0,0] row_mask:0xf bank_mask:0xf
    v_mov_b32_dpp v25, v14 quad_perm:[2,2,2,2] row_mask:0xf bank_mask:0xf
    s_nop 0
    v_add_f32_dpp v24, v13, v24 quad_perm:[1,1,1,1] row_mask:0xf bank_mask:0xf
    v_add_f32_dpp v25, v15, v25 quad_perm:[3,3,3,3] row_mask:0xf bank_mask:0xf
    v_add_f32 v24, v24, v25
    v_cndmask_b32 v26, v26, v24, s[82:83]
    v_mfma_f32_16x16x32_bf16 v[8:11], v[32:35], v[224:227], 0
    s_waitcnt vmcnt(5)
    s_cbranch_vccnz L_w_65
    s_waitcnt vmcnt(4)
L_w_65:
    buffer_load_dwordx4 v[32:35], v1, s[44:47], s69 offen offset:0 nt
    v_mfma_f32_16x16x32_bf16 v[8:11], v[36:39], v[228:231], v[8:11]
    s_waitcnt vmcnt(5)
    s_cbranch_vccnz L_w_66
    s_waitcnt vmcnt(4)
L_w_66:
    buffer_load_dwordx4 v[36:39], v1, s[44:47], s69 offen offset:256 nt
    s_add_u32 s76, s76, 1
    s_waitcnt lgkmcnt(0)
    v_readfirstlane_b32 s12, v28
    v_mov_b32 v30, s76
    ds_write_b32 v27, v30 offset:46400
    ds_read_b32 v28, v29 offset:46416
    s_cmp_lt_u32 s76, s12
    s_cselect_b64 vcc, -1, 0
    v_mfma_f32_16x16x32_bf16 v[8:11], v[40:43], v[232:235], v[8:11]
    s_waitcnt vmcnt(5)
    s_cbranch_vccnz L_w_67
    s_waitcnt vmcnt(4)
L_w_67:
    buffer_load_dwordx4 v[40:43], v1, s[44:47], s69 offen offset:2048 nt
    v_mfma_f32_16x16x32_bf16 v[8:11], v[44:47], v[236:239], v[8:11]
    s_waitcnt vmcnt(5)
    s_cbranch_vccnz L_w_68
    s_waitcnt vmcnt(4)
L_w_68:
    buffer_load_dwordx4 v[44:47], v1, s[44:47], s69 offen offset:2304 nt
    v_mfma_f32_16x16x32_bf16 v[8:11], v[48:51], v[240:243], v[8:11]
    s_waitcnt vmcnt(5)
    s_cbranch_vccnz L_w_69
    s_waitcnt vmcnt(4)
L_w_69:
    buffer_load_dwordx4 v[48:51], v1, s[44:47], s70 offen offset:0 nt
    v_mfma_f32_16x16x32_bf16 v[8:11], v[52:55], v[244:247], v[8:11]
    s_waitcnt vmcnt(5)
    s_cbranch_vccnz L_w_70
    s_waitcnt vmcnt(4)
L_w_70:
    buffer_load_dwordx4 v[52:55], v1, s[44:47], s70 offen offset:256 nt
    s_add_u32 s76, s76, 1
    s_waitcnt lgkmcnt(0)
    v_readfirstlane_b32 s12, v28
    v_mov_b32 v30, s76
    ds_write_b32 v27, v30 offset:46400
    ds_read_b32 v28, v29 offset:46416
    s_cmp_lt_u32 s76, s12
    s_cselect_b64 vcc, -1, 0
    v_mfma_f32_16x16x32_bf16 v[8:11], v[56:59], v[248:251], v[8:11]
    s_waitcnt vmcnt(5)
    s_cbranch_vccnz L_w_71
    s_waitcnt vmcnt(4)
L_w_71:
    buffer_load_dwordx4 v[56:59], v1, s[44:47], s70 offen offset:2048 nt
    v_mfma_f32_16x16x32_bf16 v[8:11], v[60:63], v[252:255], v[8:11]
    s_waitcnt vmcnt(5)
    s_cbranch_vccnz L_w_72
    s_waitcnt vmcnt(4)
L_w_72:
    buffer_load_dwordx4 v[60:63], v1, s[44:47], s70 offen offset:2304 nt
    s_add_u32 s69, s69, 65536
    s_add_u32 s70, s70, 65536
    s_nop 3
    v_mov_b32_dpp v24, v8 quad_perm:[0,0,0,0] row_mask:0xf bank_mask:0xf
    v_mov_b32_dpp v25, v10 quad_perm:[2,2,2,2] row_mask:0xf bank_mask:0xf
    s_nop 0
    v_add_f32_dpp v24, v9, v24 quad_perm:[1,1,1,1] row_mask:0xf bank_mask:0xf
    v_add_f32_dpp v25, v11, v25 quad_perm:[3,3,3,3] row_mask:0xf bank_mask:0xf
    v_add_f32 v24, v24, v25
    v_cndmask_b32 v26, v26, v24, s[84:85]
    v_mfma_f32_16x16x32_bf16 v[12:15], v[64:67], v[224:227], 0
    s_waitcnt vmcnt(5)
    s_cbranch_vccnz L_w_73
    s_waitcnt vmcnt(4)
L_w_73:
    buffer_load_dwordx4 v[64:67], v1, s[44:47], s69 offen offset:0 nt
    v_mfma_f32_16x16x32_bf16 v[12:15], v[68:71], v[228:231], v[12:15]
    s_waitcnt vmcnt(5)
    s_cbranch_vccnz L_w_74
    s_waitcnt vmcnt(4)
L_w_74:
    buffer_load_dwordx4 v[68:71], v1, s[44:47], s69 offen offset:256 nt
    s_add_u32 s76, s76, 1
    s_waitcnt lgkmcnt(0)
    v_readfirstlane_b32 s12, v28
    v_mov_b32 v30, s76
    ds_write_b32 v27, v30 offset:46400
    ds_read_b32 v28, v29 offset:46416
    s_cmp_lt_u32 s76, s12
    s_cselect_b64 vcc, -1, 0
    v_mfma_f32_16x16x32_bf16 v[12:15], v[72:75], v[232:235], v[12:15]
    s_waitcnt vmcnt(5)
    s_cbranch_vccnz L_w_75
    s_waitcnt vmcnt(4)
L_w_75:
    buffer_load_dwordx4 v[72:75], v1, s[44:47], s69 offen offset:2048 nt
    v_mfma_f32_16x16x32_bf16 v[12:15], v[76:79], v[236:239], v[12:15]
    s_waitcnt vmcnt(5)
    s_cbranch_vccnz L_w_76
    s_waitcnt vmcnt(4)
L_w_76:
    buffer_load_dwordx4 v[76:79], v1, s[44:47], s69 offen offset:2304 nt
    v_mfma_f32_16x16x32_bf16 v[12:15], v[80:83], v[240:243], v[12:15]
    s_waitcnt vmcnt(5)
    s_cbranch_vccnz L_w_77
    s_waitcnt vmcnt(4)
L_w_77:
    buffer_load_dwordx4 v[80:83], v1, s[44:47], s70 offen offset:0 nt
    v_mfma_f32_16x16x32_bf16 v[12:15], v[84:87], v[244:247], v[12:15]
    s_waitcnt vmcnt(5)
    s_cbranch_vccnz L_w_78
    s_waitcnt vmcnt(4)
L_w_78:
    buffer_load_dwordx4 v[84:87], v1, s[44:47], s70 offen offset:256 nt
    s_add_u32 s76, s76, 1
    s_waitcnt lgkmcnt(0)
    v_readfirstlane_b32 s12, v28
    v_mov_b32 v30, s76
    ds_write_b32 v27, v30 offset:46400
    ds_read_b32 v28, v29 offset:46416
    s_cmp_lt_u32 s76, s12
    s_cselect_b64 vcc, -1, 0
    v_mfma_f32_16x16x32_bf16 v[12:15], v[88:91], v[248:251], v[12:15]
    s_waitcnt vmcnt(5)
    s_cbranch_vccnz L_w_79
    s_waitcnt vmcnt(4)
L_w_79:
    buffer_load_dwordx4 v[88:91], v1, s[44:47], s70 offen offset:2048 nt
    v_mfma_f32_16x16x32_bf16 v[12:15], v[92:95], v[252:255], v[12:15]
    s_waitcnt vmcnt(5)
    s_cbranch_vccnz L_w_80
    s_waitcnt vmcnt(4)
L_w_80:
    buffer_load_dwordx4 v[92:95], v1, s[44:47], s70 offen offset:2304 nt
    s_add_u32 s69, s69, 65536
    s_add_u32 s70, s70, 65536
    s_nop 3
    v_mov_b32_dpp v24, v12 quad_perm:[0,0,0,0] row_mask:0xf bank_mask:0xf
    v_mov_b32_dpp v25, v14 quad_perm:[2,2,2,2] row_mask:0xf bank_mask:0xf
    s_nop 0
    v_add_f32_dpp v24, v13, v24 quad_perm:[1,1,1,1] row_mask:0xf bank_mask:0xf
    v_add_f32_dpp v25, v15, v25 quad_perm:[3,3,3,3] row_mask:0xf bank_mask:0xf
    v_add_f32 v24, v24, v25
    v_cndmask_b32 v26, v26, v24, s[86:87]
    v_mov_b32 v16, v17
    v_mov_b32 v17, v18
    v_mov_b32 v18, v19
    v_mov_b32 v19, v20
    v_mov_b32 v20, v21
    v_mov_b32 v21, v22
    v_mov_b32 v22, v23
    v_mov_b32 v23, v26
    s_sub_u32 s71, s71, 1
    s_cmp_lg_u32 s71, 0
    s_cbranch_scc1 L_kloop
    s_barrier
    v_mfma_f32_16x16x32_bf16 v[8:11], v[96:99], v[224:227], 0
    v_mfma_f32_16x16x32_bf16 v[8:11], v[100:103], v[228:231], v[8:11]
    v_mfma_f32_16x16x32_bf16 v[8:11], v[104:107], v[232:235], v[8:11]
    v_mfma_f32_16x16x32_bf16 v[8:11], v[108:111], v[236:239], v[8:11]
    v_mfma_f32_16x16x32_bf16 v[8:11], v[112:115], v[240:243], v[8:11]
    v_mfma_f32_16x16x32_bf16 v[8:11], v[116:119], v[244:247], v[8:11]
    v_mfma_f32_16x16x32_bf16 v[8:11], v[120:123], v[248:251], v[8:11]
    v_mfma_f32_16x16x32_bf16 v[8:11], v[124:127], v[252:255], v[8:11]
    s_nop 7
    v_mov_b32_dpp v24, v8 quad_perm:[0,0,0,0] row_mask:0xf bank_mask:0xf
    v_mov_b32_dpp v25, v10 quad_perm:[2,2,2,2] row_mask:0xf bank_mask:0xf
    s_nop 0
    v_add_f32_dpp v24, v9, v24 quad_perm:[1,1,1,1] row_mask:0xf bank_mask:0xf
    v_add_f32_dpp v25, v11, v25 quad_perm:[3,3,3,3] row_mask:0xf bank_mask:0xf
    v_add_f32 v26, v24, v25
    v_mfma_f32_16x16x32_bf16 v[12:15], v[128:131], v[224:227], 0
    v_mfma_f32_16x16x32_bf16 v[12:15], v[132:135], v[228:231], v[12:15]
    v_mfma_f32_16x16x32_bf16 v[12:15], v[136:139], v[232:235], v[12:15]
    v_mfma_f32_16x16x32_bf16 v[12:15], v[140:143], v[236:239], v[12:15]
    v_mfma_f32_16x16x32_bf16 v[12:15], v[144:147], v[240:243], v[12:15]
    v_mfma_f32_16x16x32_bf16 v[12:15], v[148:151], v[244:247], v[12:15]
    v_mfma_f32_16x16x32_bf16 v[12:15], v[152:155], v[248:251], v[12:15]
    v_mfma_f32_16x16x32_bf16 v[12:15], v[156:159], v[252:255], v[12:15]
    s_nop 7
    v_mov_b32_dpp v24, v12 quad_perm:[0,0,0,0] row_mask:0xf bank_mask:0xf
    v_mov_b32_dpp v25, v14 quad_perm:[2,2,2,2] row_mask:0xf bank_mask:0xf
    s_nop 0
    v_add_f32_dpp v24, v13, v24 quad_perm:[1,1,1,1] row_mask:0xf bank_mask:0xf
    v_add_f32_dpp v25, v15, v25 quad_perm:[3,3,3,3] row_mask:0xf bank_mask:0xf
    v_add_f32 v24, v24, v25
    v_cndmask_b32 v26, v26, v24, s[82:83]
    v_mfma_f32_16x16x32_bf16 v[8:11], v[32:35], v[224:227], 0
    v_mfma_f32_16x16x32_bf16 v[8:11], v[36:39], v[228:231], v[8:11]
    v_mfma_f32_16x16x32_bf16 v[8:11], v[40:43], v[232:235], v[8:11]
    v_mfma_f32_16x16x32_bf16 v[8:11], v[44:47], v[236:239], v[8:11]
    v_mfma_f32_16x16x32_bf16 v[8:11], v[48:51], v[240:243], v[8:11]
    v_mfma_f32_16x16x32_bf16 v[8:11], v[52:55], v[244:247], v[8:11]
    v_mfma_f32_16x16x32_bf16 v[8:11], v[56:59], v[248:251], v[8:11]
    v_mfma_f32_16x16x32_bf16 v[8:11], v[60:63], v[252:255], v[8:11]
    s_nop 7
    v_mov_b32_dpp v24, v8 quad_perm:[0,0,0,0] row_mask:0xf bank_mask:0xf
    v_mov_b32_dpp v25, v10 quad_perm:[2,2,2,2] row_mask:0xf bank_mask:0xf
    s_nop 0
    v_add_f32_dpp v24, v9, v24 quad_perm:[1,1,1,1] row_mask:0xf bank_mask:0xf
    v_add_f32_dpp v25, v11, v25 quad_perm:[3,3,3,3] row_mask:0xf bank_mask:0xf
    v_add_f32 v24, v24, v25
    v_cndmask_b32 v26, v26, v24, s[84:85]
    v_mfma_f32_16x16x32_bf16 v[12:15], v[64:67], v[224:227], 0
    v_mfma_f32_16x16x32_bf16 v[12:15], v[68:71], v[228:231], v[12:15]
    s_waitcnt vmcnt(5)
    v_mfma_f32_16x16x32_bf16 v[12:15], v[72:75], v[232:235], v[12:15]
    s_waitcnt vmcnt(4)
    v_mfma_f32_16x16x32_bf16 v[12:15], v[76:79], v[236:239], v[12:15]
    s_waitcnt vmcnt(3)
    v_mfma_f32_16x16x32_bf16 v[12:15], v[80:83], v[240:243], v[12:15]
    s_waitcnt vmcnt(2)
    v_mfma_f32_16x16x32_bf16 v[12:15], v[84:87], v[244:247], v[12:15]
    s_waitcnt vmcnt(1)
    v_mfma_f32_16x16x32_bf16 v[12:15], v[88:91], v[248:251], v[12:15]
    s_waitcnt vmcnt(0)
    v_mfma_f32_16x16x32_bf16 v[12:15], v[92:95], v[252:255], v[12:15]
    s_nop 7
    v_mov_b32_dpp v24, v12 quad_perm:[0,0,0,0] row_mask:0xf bank_mask:0xf
    v_mov_b32_dpp v25, v14 quad_perm:[2,2,2,2] row_mask:0xf bank_mask:0xf
    s_nop 0
    v_add_f32_dpp v24, v13, v24 quad_perm:[1,1,1,1] row_mask:0xf bank_mask:0xf
    v_add_f32_dpp v25, v15, v25 quad_perm:[3,3,3,3] row_mask:0xf bank_mask:0xf
    v_add_f32 v24, v24, v25
    v_cndmask_b32 v26, v26, v24, s[86:87]
    v_mov_b32 v16, v17
    v_mov_b32 v17, v18
    v_mov_b32 v18, v19
    v_mov_b32 v19, v20
    v_mov_b32 v20, v21
    v_mov_b32 v21, v22
    v_mov_b32 v22, v23
    v_mov_b32 v23, v26
    v_cvt_pk_bf16_f32 v17, v16, v17
    v_lshlrev_b32 v16, 16, v17
    v_and_b32 v17, 0xffff0000, v17
    v_cvt_pk_bf16_f32 v19, v18, v19
    v_lshlrev_b32 v18, 16, v19
    v_and_b32 v19, 0xffff0000, v19
    v_cvt_pk_bf16_f32 v21, v20, v21
    v_lshlrev_b32 v20, 16, v21
    v_and_b32 v21, 0xffff0000, v21
    v_cvt_pk_bf16_f32 v23, v22, v23
    v_lshlrev_b32 v22, 16, v23
    v_and_b32 v23, 0xffff0000, v23
    v_max3_f32 v2, v16, v17, v18
    v_max3_f32 v3, v19, v20, v21
    v_max3_f32 v2, v2, v22, v23
    v_max_f32 v2, v2, v3
    s_nop 1
    v_max_f32_dpp v2, v2, v2 row_ror:8 row_mask:0xf bank_mask:0xf
    s_nop 1
    v_max_f32_dpp v2, v2, v2 row_ror:4 row_mask:0xf bank_mask:0xf
    s_nop 1
    v_max_f32_dpp v2, v2, v2 row_ror:2 row_mask:0xf bank_mask:0xf
    s_nop 1
    v_max_f32_dpp v2, v2, v2 row_ror:1 row_mask:0xf bank_mask:0xf
    v_mov_b32 v3, v2
    s_nop 1
    v_permlane16_swap_b32 v2, v3
    v_max_f32 v2, v2, v3
    v_mov_b32 v3, v2
    s_nop 1
    v_permlane32_swap_b32 v2, v3
    v_max_f32 v2, v2, v3
    v_sub_f32 v16, v16, v2
    v_mul_f32 v16, 0x3db8aa3b, v16
    v_sub_f32 v17, v17, v2
    v_mul_f32 v17, 0x3db8aa3b, v17
    v_sub_f32 v18, v18, v2
    v_mul_f32 v18, 0x3db8aa3b, v18
    v_sub_f32 v19, v19, v2
    v_mul_f32 v19, 0x3db8aa3b, v19
    v_sub_f32 v20, v20, v2
    v_mul_f32 v20, 0x3db8aa3b, v20
    v_sub_f32 v21, v21, v2
    v_mul_f32 v21, 0x3db8aa3b, v21
    v_sub_f32 v22, v22, v2
    v_mul_f32 v22, 0x3db8aa3b, v22
    v_sub_f32 v23, v23, v2
    v_mul_f32 v23, 0x3db8aa3b, v23
    v_exp_f32 v16, v16
    v_exp_f32 v17, v17
    v_exp_f32 v18, v18
    v_exp_f32 v19, v19
    v_exp_f32 v20, v20
    v_exp_f32 v21, v21
    v_exp_f32 v22, v22
    v_exp_f32 v23, v23
    s_lshl_b32 s12, s9, 11
    v_lshl_add_u32 v1, v0, 2, s12
    v_add_f32 v3, v16, v17
    v_add_f32 v8, v18, v19
    v_add_f32 v9, v20, v21
    v_add_f32 v10, v22, v23
    v_cvt_pk_bf16_f32 v16, v16, v16
    ds_write_b32 v1, v16 offset:4096
    v_cvt_pk_bf16_f32 v17, v17, v17
    ds_write_b32 v1, v17 offset:4352
    v_cvt_pk_bf16_f32 v18, v18, v18
    ds_write_b32 v1, v18 offset:4608
    v_cvt_pk_bf16_f32 v19, v19, v19
    ds_write_b32 v1, v19 offset:4864
    v_cvt_pk_bf16_f32 v20, v20, v20
    ds_write_b32 v1, v20 offset:5120
    v_cvt_pk_bf16_f32 v21, v21, v21
    ds_write_b32 v1, v21 offset:5376
    v_cvt_pk_bf16_f32 v22, v22, v22
    ds_write_b32 v1, v22 offset:5632
    v_cvt_pk_bf16_f32 v23, v23, v23
    ds_write_b32 v1, v23 offset:5888
    v_add_f32 v3, v3, v8
    v_add_f32 v9, v9, v10
    v_add_f32 v3, v3, v9
    s_nop 1
    v_add_f32_dpp v3, v3, v3 row_ror:8 row_mask:0xf bank_mask:0xf
    s_nop 1
    v_add_f32_dpp v3, v3, v3 row_ror:4 row_mask:0xf bank_mask:0xf
    s_nop 1
    v_add_f32_dpp v3, v3, v3 row_ror:2 row_mask:0xf bank_mask:0xf
    s_nop 1
    v_add_f32_dpp v3, v3, v3 row_ror:1 row_mask:0xf bank_mask:0xf
    v_mov_b32 v8, v3
    s_nop 1
    v_permlane16_swap_b32 v3, v8
    v_add_f32 v3, v3, v8
    v_mov_b32 v8, v3
    s_nop 1
    v_permlane32_swap_b32 v3, v8
    v_add_f32 v3, v3, v8
    s_lshl_b32 s12, s9, 3
    v_mov_b32 v1, s12
    ds_write_b64 v1, v[2:3] offset:12288
    s_waitcnt lgkmcnt(0)
    s_barrier
    s_lshl_b32 s12, s7, 7
    v_mov_b32 v3, s12
    global_load_dword v2, v3, s[40:41] offset:2048 sc1
    s_waitcnt vmcnt(0)
    v_readfirstlane_b32 s68, v2
    s_nop 0
    s_add_u32 s42, s68, 0x10001
    s_and_b32 s68, s42, 15
    s_and_b32 s43, s42, 0xffff0000
    s_lshl_b32 s12, s7, 16
    s_add_u32 s12, s12, 532480
    s_add_u32 s56, s40, s12
    s_addc_u32 s57, s41, 0
    s_mov_b32 s58, 65536
    s_mov_b32 s59, 0x20000
    v_mov_b32 v1, 0
    ds_read_b128 v[8:11], v1 offset:12288
    ds_read_b128 v[12:15], v1 offset:12304
    s_waitcnt lgkmcnt(0)
    v_max3_f32 v2, v8, v10, v12
    v_max_f32 v2, v2, v14
    v_sub_f32 v16, v8, v2
    v_mul_f32 v16, 0x3db8aa3b, v16
    v_sub_f32 v17, v10, v2
    v_mul_f32 v17, 0x3db8aa3b, v17
    v_sub_f32 v18, v12, v2
    v_mul_f32 v18, 0x3db8aa3b, v18
    v_sub_f32 v19, v14, v2
    v_mul_f32 v19, 0x3db8aa3b, v19
    v_exp_f32 v16, v16
    v_exp_f32 v17, v17
    v_exp_f32 v18, v18
    v_exp_f32 v19, v19
    s_nop 0
    v_mul_f32 v3, v16, v9
    v_fmac_f32 v3, v17, v11
    v_fmac_f32 v3, v18, v13
    v_fmac_f32 v3, v19, v15
    v_and_b32 v3, 0xfffffff0, v3
    v_or_b32 v20, s68, v2
    v_or_b32 v21, s68, v3
    v_mov_b32 v22, s68
    v_mov_b32 v23, s68
    s_lshl_b32 s12, s10, 11
    s_cmp_lg_u32 s9, 0
    s_cbranch_scc1 L_noml_81
    s_mov_b64 exec, 1
    buffer_store_dwordx4 v[20:23], off, s[56:59], s12 offset:1792 sc1
    s_mov_b64 exec, -1
L_noml_81:
    s_lshl_b32 s12, s5, 7
    s_add_u32 s12, s12, 4096
    v_and_b32 v13, 15, v0
    v_lshl_add_u32 v13, v13, 2, s12
    s_lshl_b32 s11, s7, 1
    s_add_u32 s11, s11, s6
    s_lshl_b32 s11, s11, 2
    s_add_u32 s12, s12, s11
    v_mov_b32 v12, s12
    v_and_b32 v14, 31, v0
    v_lshlrev_b32 v14, 11, v14
    v_mov_b32 v15, 0
    ds_read_b32 v8, v15 offset:46420
    s_mov_b32 s84, 0
    s_mov_b32 s82, -48
    s_getreg_b32 s11, hwreg(HW_REG_XCC_ID, 0, 1)
    s_mul_i32 s11, s11, 32
    s_sub_i32 s11, s11, 16
    s_add_i32 s82, s82, s11
    s_mov_b32 s83, s82
    s_mov_b32 s85, 0
    s_waitcnt lgkmcnt(0)
    v_readfirstlane_b32 s86, v8
    s_mul_i32 s12, s5, 229376
    s_add_u32 s48, s24, s12
    s_addc_u32 s49, s25, 0
    s_mov_b32 s50, 229376
    s_mov_b32 s51, 0x20000
    s_lshl_b32 s11, s7, 1
    s_add_u32 s11, s11, s6
    s_lshl_b32 s11, s11, 2
    s_add_u32 s11, s11, s9
    s_mul_i32 s11, s11, 3584
    v_lshlrev_b32 v24, 6, v0
    s_mov_b32 exec_hi, 0xffffff
    buffer_load_dword v31, v24, s[48:51], s11 offen
    s_mov_b32 exec_hi, -1
    s_mul_i32 s70, s9, 14336
    s_add_u32 s70, s70, 62848
    v_mov_b32 v24, 0xffff
    v_and_b32 v25, 4, v0
    v_cmp_eq_u32 vcc, 0, v25
    v_and_b32 v252, 3, v0
    v_mul_u32_u24 v252, 0x5555, v252
    v_cndmask_b32 v4, 0, v24, vcc
    v_xor_b32 v5, v4, v24
    v_lshlrev_b32 v6, 16, v4
    v_lshlrev_b32 v7, 16, v5
    v_mov_b32 v200, 0
    v_mov_b32 v201, 0
    v_mov_b32 v202, 0
    v_mov_b32 v203, 0
    v_mov_b32 v204, 0
    v_mov_b32 v205, 0
    v_mov_b32 v206, 0
    v_mov_b32 v207, 0
    v_mov_b32 v208, 0
    v_mov_b32 v209, 0
    v_mov_b32 v210, 0
    v_mov_b32 v211, 0
    v_mov_b32 v212, 0
    v_mov_b32 v213, 0
    v_mov_b32 v214, 0
    v_mov_b32 v215, 0
    v_mov_b32 v216, 0
    v_mov_b32 v217, 0
    v_mov_b32 v218, 0
    v_mov_b32 v219, 0
    v_mov_b32 v220, 0
    v_mov_b32 v221, 0
    v_mov_b32 v222, 0
    v_mov_b32 v223, 0
    v_mov_b32 v224, 0
    v_mov_b32 v225, 0
    v_mov_b32 v226, 0
    v_mov_b32 v227, 0
    v_lshl_add_u32 v253, v0, 4, s70
    s_lshl_b32 s12, s7, 16
    s_add_u32 s12, s12, 1056768
    s_add_u32 s60, s40, s12
    s_addc_u32 s61, s41, 0
    s_mov_b32 s62, 65536
    s_mov_b32 s63, 0x20000
    s_mul_i32 s12, s7, 896
    s_add_u32 s64, s36, s12
    s_addc_u32 s65, s37, 0
    s_mov_b32 s66, 896
    s_mov_b32 s67, 0x20000
    s_mov_b32 s52, s34
    s_mov_b32 s53, s35
    s_mov_b32 s54, 896
    s_mov_b32 s55, 0x20000
    v_and_b32 v24, 7, v0
    s_mul_i32 s12, s8, 56
    v_lshl_add_u32 v25, v24, 3, s12
    v_lshrrev_b32 v24, 4, v0
    v_lshl_add_u32 v255, v24, 1, v25
    buffer_load_ushort v254, v255, s[52:55], 0 offen
    s_xor_b32 s12, s10, 16
    s_lshl_b32 s12, s12, 11
    s_mov_b32 s71, 1048576
L_ml_82:
    buffer_load_dwordx4 v[28:31], off, s[56:59], s12 offset:1792 sc1
    s_waitcnt vmcnt(0)
    v_xor_b32 v22, s68, v28
    v_xor_b32 v23, s68, v29
    v_xor_b32 v30, s68, v30
    v_xor_b32 v31, s68, v31
    v_and_b32 v28, 0xffff, v22
    v_and_b32 v29, 15, v23
    v_or3_b32 v24, v28, v29, v30
    v_or_b32 v24, v24, v31
    v_cmp_eq_u32 vcc, 0, v24
    s_cbranch_vccnz L_ml_ok_83
    s_sleep 16
    s_sub_u32 s71, s71, 1
    s_cmp_lg_u32 s71, 0
    s_cbranch_scc1 L_ml_82
L_ml_ok_83:
    v_max_f32 v24, v2, v22
    v_sub_f32 v25, v2, v24
    v_sub_f32 v26, v22, v24
    v_mul_f32 v25, 0x3db8aa3b, v25
    v_mul_f32 v26, 0x3db8aa3b, v26
    v_exp_f32 v25, v25
    v_exp_f32 v26, v26
    s_nop 0
    v_mul_f32 v27, v25, v3
    v_fmac_f32 v27, v26, v23
    v_rcp_f32 v27, v27
    s_nop 0
    v_mul_f32 v27, v27, v25
    v_mul_f32 v16, v16, v27
    v_mul_f32 v17, v17, v27
    v_mul_f32 v18, v18, v27
    v_mul_f32 v19, v19, v27
    s_nop 0
    v_readfirstlane_b32 s76, v16
    v_readfirstlane_b32 s77, v17
    v_readfirstlane_b32 s78, v18
    v_readfirstlane_b32 s79, v19
    s_mul_i32 s12, s5, 229376
    s_add_u32 s48, s24, s12
    s_addc_u32 s49, s25, 0
    s_mov_b32 s50, 229376
    s_mov_b32 s51, 0x20000
    s_mul_i32 s69, s9, 28672
    v_lshrrev_b32 v1, 4, v0
    v_mul_u32_u24 v1, 1792, v1
    v_and_b32 v24, 15, v0
    v_lshl_add_u32 v1, v24, 4, v1
    s_cmp_lg_u32 s9, 3
    s_cbranch_scc1 L_nm_84
    s_call_b64 s[14:15], L_mon
L_nm_84:
    buffer_load_dwordx4 v[32:35], v1, s[48:51], s69 offen offset:0
    buffer_load_dwordx4 v[40:43], v1, s[48:51], s69 offen offset:256
    s_cmp_lg_u32 s9, 3
    s_cbranch_scc1 L_nm_85
    s_call_b64 s[14:15], L_mon
L_nm_85:
    s_waitcnt vmcnt(1)
    buffer_load_dwordx4 v[48:51], v1, s[48:51], s69 offen offset:512
    s_waitcnt vmcnt(1)
    buffer_load_dwordx4 v[56:59], v1, s[48:51], s69 offen offset:768
    s_cmp_lg_u32 s9, 3
    s_cbranch_scc1 L_nm_86
    s_call_b64 s[14:15], L_mon
L_nm_86:
    s_waitcnt vmcnt(1)
    buffer_load_dwordx4 v[64:67], v1, s[48:51], s69 offen offset:1024
    s_waitcnt vmcnt(1)
    buffer_load_dwordx4 v[72:75], v1, s[48:51], s69 offen offset:1280
    s_cmp_lg_u32 s9, 3
    s_cbranch_scc1 L_nm_87
    s_call_b64 s[14:15], L_mon
L_nm_87:
    s_waitcnt vmcnt(1)
    buffer_load_dwordx4 v[80:83], v1, s[48:51], s69 offen offset:1536
    s_add_u32 s69, s69, 7168
    s_waitcnt vmcnt(1)
    buffer_load_dwordx4 v[88:91], v1, s[48:51], s69 offen offset:0
    s_cmp_lg_u32 s9, 3
    s_cbranch_scc1 L_nm_88
    s_call_b64 s[14:15], L_mon
L_nm_88:
    s_waitcnt vmcnt(1)
    buffer_load_dwordx4 v[96:99], v1, s[48:51], s69 offen offset:256
    s_waitcnt vmcnt(1)
    buffer_load_dwordx4 v[104:107], v1, s[48:51], s69 offen offset:512
    s_cmp_lg_u32 s9, 3
    s_cbranch_scc1 L_nm_89
    s_call_b64 s[14:15], L_mon
L_nm_89:
    s_waitcnt vmcnt(1)
    buffer_load_dwordx4 v[112:115], v1, s[48:51], s69 offen offset:768
    s_waitcnt vmcnt(1)
    buffer_load_dwordx4 v[120:123], v1, s[48:51], s69 offen offset:1024
    s_cmp_lg_u32 s9, 3
    s_cbranch_scc1 L_nm_90
    s_call_b64 s[14:15], L_mon
L_nm_90:
    s_waitcnt vmcnt(1)
    buffer_load_dwordx4 v[128:131], v1, s[48:51], s69 offen offset:1280
    s_waitcnt vmcnt(1)
    buffer_load_dwordx4 v[136:139], v1, s[48:51], s69 offen offset:1536
    s_add_u32 s69, s69, 7168
    s_cmp_lg_u32 s9, 3
    s_cbranch_scc1 L_nm_91
    s_call_b64 s[14:15], L_mon
L_nm_91:
    s_waitcnt vmcnt(1)
    buffer_load_dwordx4 v[36:39], v1, s[48:51], s69 offen offset:0
    s_waitcnt vmcnt(1)
    buffer_load_dwordx4 v[44:47], v1, s[48:51], s69 offen offset:256
    s_cmp_lg_u32 s9, 3
    s_cbranch_scc1 L_nm_92
    s_call_b64 s[14:15], L_mon
L_nm_92:
    s_waitcnt vmcnt(1)
    buffer_load_dwordx4 v[52:55], v1, s[48:51], s69 offen offset:512
    s_waitcnt vmcnt(1)
    buffer_load_dwordx4 v[60:63], v1, s[48:51], s69 offen offset:768
    s_cmp_lg_u32 s9, 3
    s_cbranch_scc1 L_nm_93
    s_call_b64 s[14:15], L_mon
L_nm_93:
    s_waitcnt vmcnt(1)
    buffer_load_dwordx4 v[68:71], v1, s[48:51], s69 offen offset:1024
    s_waitcnt vmcnt(1)
    buffer_load_dwordx4 v[76:79], v1, s[48:51], s69 offen offset:1280
    s_cmp_lg_u32 s9, 3
    s_cbranch_scc1 L_nm_94
    s_call_b64 s[14:15], L_mon
L_nm_94:
    s_waitcnt vmcnt(1)
    buffer_load_dwordx4 v[84:87], v1, s[48:51], s69 offen offset:1536
    s_add_u32 s69, s69, 7168
    s_waitcnt vmcnt(1)
    buffer_load_dwordx4 v[92:95], v1, s[48:51], s69 offen offset:0
    s_cmp_lg_u32 s9, 3
    s_cbranch_scc1 L_nm_95
    s_call_b64 s[14:15], L_mon
L_nm_95:
    s_waitcnt vmcnt(1)
    buffer_load_dwordx4 v[100:103], v1, s[48:51], s69 offen offset:256
    s_waitcnt vmcnt(1)
    buffer_load_dwordx4 v[108:111], v1, s[48:51], s69 offen offset:512
    s_cmp_lg_u32 s9, 3
    s_cbranch_scc1 L_nm_96
    s_call_b64 s[14:15], L_mon
L_nm_96:
    s_waitcnt vmcnt(1)
    buffer_load_dwordx4 v[116:119], v1, s[48:51], s69 offen offset:768
    s_waitcnt vmcnt(1)
    buffer_load_dwordx4 v[124:127], v1, s[48:51], s69 offen offset:1024
    s_cmp_lg_u32 s9, 3
    s_cbranch_scc1 L_nm_97
    s_call_b64 s[14:15], L_mon
L_nm_97:
    s_waitcnt vmcnt(1)
    buffer_load_dwordx4 v[132:135], v1, s[48:51], s69 offen offset:1280
    s_waitcnt vmcnt(1)
    buffer_load_dwordx4 v[140:143], v1, s[48:51], s69 offen offset:1536
    s_add_u32 s69, s69, 93184
    s_cmp_lg_u32 s9, 3
    s_cbranch_scc1 L_nm_98
    s_call_b64 s[14:15], L_mon
L_nm_98:
    s_waitcnt vmcnt(1)
    buffer_load_dwordx4 v[144:147], v1, s[48:51], s69 offen offset:0
    s_waitcnt vmcnt(1)
    buffer_load_dwordx4 v[152:155], v1, s[48:51], s69 offen offset:256
    s_cmp_lg_u32 s9, 3
    s_cbranch_scc1 L_nm_99
    s_call_b64 s[14:15], L_mon
L_nm_99:
    s_waitcnt vmcnt(1)
    buffer_load_dwordx4 v[160:163], v1, s[48:51], s69 offen offset:512
    s_waitcnt vmcnt(1)
    buffer_load_dwordx4 v[168:171], v1, s[48:51], s69 offen offset:768
    s_cmp_lg_u32 s9, 3
    s_cbranch_scc1 L_nm_100
    s_call_b64 s[14:15], L_mon
L_nm_100:
    s_waitcnt vmcnt(1)
    buffer_load_dwordx4 v[176:179], v1, s[48:51], s69 offen offset:1024
    s_waitcnt vmcnt(1)
    buffer_load_dwordx4 v[184:187], v1, s[48:51], s69 offen offset:1280
    s_cmp_lg_u32 s9, 3
    s_cbranch_scc1 L_nm_101
    s_call_b64 s[14:15], L_mon
L_nm_101:
    s_waitcnt vmcnt(1)
    buffer_load_dwordx4 v[192:195], v1, s[48:51], s69 offen offset:1536
    s_add_u32 s69, s69, 7168
    s_add_u32 m0, s70, 0
    s_waitcnt vmcnt(1)
    buffer_load_dwordx4 v1, s[48:51], s69 offen offset:0  lds
    s_cmp_lg_u32 s9, 3
    s_cbranch_scc1 L_nm_102
    s_call_b64 s[14:15], L_mon
L_nm_102:
    s_add_u32 m0, s70, 1792
    s_waitcnt vmcnt(1)
    buffer_load_dwordx4 v1, s[48:51], s69 offen offset:256  lds
    s_add_u32 m0, s70, 3584
    s_waitcnt vmcnt(1)
    buffer_load_dwordx4 v1, s[48:51], s69 offen offset:512  lds
    s_cmp_lg_u32 s9, 3
    s_cbranch_scc1 L_nm_103
    s_call_b64 s[14:15], L_mon
L_nm_103:
    s_add_u32 m0, s70, 5376
    s_waitcnt vmcnt(1)
    buffer_load_dwordx4 v1, s[48:51], s69 offen offset:768  lds
    s_add_u32 m0, s70, 7168
    s_waitcnt vmcnt(1)
    buffer_load_dwordx4 v1, s[48:51], s69 offen offset:1024  lds
    s_cmp_lg_u32 s9, 3
    s_cbranch_scc1 L_nm_104
    s_call_b64 s[14:15], L_mon
L_nm_104:
    s_add_u32 m0, s70, 8960
    s_waitcnt vmcnt(1)
    buffer_load_dwordx4 v1, s[48:51], s69 offen offset:1280  lds
    s_add_u32 m0, s70, 10752
    s_waitcnt vmcnt(1)
    buffer_load_dwordx4 v1, s[48:51], s69 offen offset:1536  lds
    s_add_u32 s69, s69, 7168
    s_cmp_lg_u32 s9, 3
    s_cbranch_scc1 L_nm_105
    s_call_b64 s[14:15], L_mon
L_nm_105:
    s_waitcnt vmcnt(1)
    buffer_load_dwordx4 v[148:151], v1, s[48:51], s69 offen offset:0
    s_waitcnt vmcnt(1)
    buffer_load_dwordx4 v[156:159], v1, s[48:51], s69 offen offset:256
    s_cmp_lg_u32 s9, 3
    s_cbranch_scc1 L_nm_106
    s_call_b64 s[14:15], L_mon
L_nm_106:
    s_waitcnt vmcnt(1)
    buffer_load_dwordx4 v[164:167], v1, s[48:51], s69 offen offset:512
    s_waitcnt vmcnt(1)
    buffer_load_dwordx4 v[172:175], v1, s[48:51], s69 offen offset:768
    s_cmp_lg_u32 s9, 3
    s_cbranch_scc1 L_nm_107
    s_call_b64 s[14:15], L_mon
L_nm_107:
    s_waitcnt vmcnt(1)
    buffer_load_dwordx4 v[180:183], v1, s[48:51], s69 offen offset:1024
    s_waitcnt vmcnt(1)
    buffer_load_dwordx4 v[188:191], v1, s[48:51], s69 offen offset:1280
    s_cmp_lg_u32 s9, 3
    s_cbranch_scc1 L_nm_108
    s_call_b64 s[14:15], L_mon
L_nm_108:
    s_waitcnt vmcnt(1)
    buffer_load_dwordx4 v[196:199], v1, s[48:51], s69 offen offset:1536
    s_add_u32 s69, s69, 7168
    s_add_u32 m0, s70, 1024
    s_waitcnt vmcnt(1)
    buffer_load_dwordx4 v1, s[48:51], s69 offen offset:0  lds
    s_cmp_lg_u32 s9, 3
    s_cbranch_scc1 L_nm_109
    s_call_b64 s[14:15], L_mon
L_nm_109:
    s_add_u32 m0, s70, 2816
    s_waitcnt vmcnt(1)
    buffer_load_dwordx4 v1, s[48:51], s69 offen offset:256  lds
    s_add_u32 m0, s70, 4608
    s_waitcnt vmcnt(1)
    buffer_load_dwordx4 v1, s[48:51], s69 offen offset:512  lds
    s_cmp_lg_u32 s9, 3
    s_cbranch_scc1 L_nm_110
    s_call_b64 s[14:15], L_mon
L_nm_110:
    s_add_u32 m0, s70, 6400
    s_waitcnt vmcnt(1)
    buffer_load_dwordx4 v1, s[48:51], s69 offen offset:768  lds
    s_add_u32 m0, s70, 8192
    s_waitcnt vmcnt(1)
    buffer_load_dwordx4 v1, s[48:51], s69 offen offset:1024  lds
    s_cmp_lg_u32 s9, 3
    s_cbranch_scc1 L_nm_111
    s_call_b64 s[14:15], L_mon
L_nm_111:
    s_add_u32 m0, s70, 9984
    s_waitcnt vmcnt(1)
    buffer_load_dwordx4 v1, s[48:51], s69 offen offset:1280  lds
    s_add_u32 m0, s70, 11776
    s_waitcnt vmcnt(1)
    buffer_load_dwordx4 v1, s[48:51], s69 offen offset:1536  lds
    s_add_u32 s69, s69, 7168
    s_waitcnt vmcnt(0)
    v_bfe_u32 v1, v0, 4, 1
    v_lshlrev_b32 v1, 2, v1
    v_bfe_u32 v2, v0, 3, 1
    v_add_u32 v1, v1, v2
    v_mul_u32_u24 v1, 144, v1
    v_lshrrev_b32 v2, 5, v0
    v_lshl_add_u32 v1, v2, 3, v1
    s_lshl_b32 s12, s9, 4
    v_add_u32 v1, s12, v1
    v_and_b32 v2, 15, v0
    v_lshlrev_b32 v2, 5, v2
    v_and_b32 v3, 16, v0
    v_add_u32 v2, v2, v3
    s_mul_i32 s12, s9, 3616
    v_add_u32 v31, s12, v2
    v_and_b32 v3, 32, v0
    v_lshl_add_u32 v2, v3, 6, v31
    v_and_b32 v3, 3, v0
    v_mul_u32_u24 v3, 3616, v3
    v_lshrrev_b32 v28, 2, v0
    v_mul_u32_u24 v29, 28, v28
    v_add_u32 v3, v29, v3
    s_mul_i32 s12, s9, 448
    s_add_u32 s12, s12, 16960
    v_add_u32 v3, s12, v3
    v_add_u32 v30, 1792, v3
    v_lshlrev_b32 v28, 4, v28
    v_mov_b32 v29, 0xffff
    s_lshl_b32 s69, s10, 11
    s_lshl_b32 s12, s9, 8
    s_add_u32 s69, s69, s12
    s_mov_b32 s80, 0
    s_mov_b32 s81, -1
    s_cmp_lg_u32 s9, 3
    s_cbranch_scc1 L_nm_112
    s_mov_b32 s71, 1048576
L_ml_113:
    s_call_b64 s[14:15], L_mon
    s_cmp_ge_u32 s87, 496
    s_cbranch_scc1 L_nm_112
    s_sleep 12
    s_sub_u32 s71, s71, 1
    s_cmp_lg_u32 s71, 0
    s_cbranch_scc1 L_ml_113
L_nm_112:
    s_barrier
    ds_read_b64 v[8:9], v1 offset:12352
    ds_read_b64 v[10:11], v1 offset:12640
    ds_read_b64 v[12:13], v1 offset:13504
    ds_read_b64 v[14:15], v1 offset:13792
    ds_read_b64 v[16:17], v1 offset:14656
    ds_read_b64 v[18:19], v1 offset:14944
    ds_read_b64 v[20:21], v1 offset:15808
    ds_read_b64 v[22:23], v1 offset:16096
    s_waitcnt lgkmcnt(6)
    v_pk_mul_f32 v[8:9], v[8:9], s[76:77] op_sel:[0,0] op_sel_hi:[1,0]
    v_pk_mul_f32 v[10:11], v[10:11], s[76:77] op_sel:[0,0] op_sel_hi:[1,0]
    s_waitcnt lgkmcnt(4)
    v_pk_fma_f32 v[8:9], v[12:13], s[76:77], v[8:9] op_sel:[0,1,0] op_sel_hi:[1,1,1]
    v_pk_fma_f32 v[10:11], v[14:15], s[76:77], v[10:11] op_sel:[0,1,0] op_sel_hi:[1,1,1]
    s_waitcnt lgkmcnt(2)
    v_pk_fma_f32 v[8:9], v[16:17], s[78:79], v[8:9] op_sel:[0,0,0] op_sel_hi:[1,0,1]
    v_pk_fma_f32 v[10:11], v[18:19], s[78:79], v[10:11] op_sel:[0,0,0] op_sel_hi:[1,0,1]
    s_waitcnt lgkmcnt(0)
    v_pk_fma_f32 v[8:9], v[20:21], s[78:79], v[8:9] op_sel:[0,1,0] op_sel_hi:[1,1,1]
    v_pk_fma_f32 v[10:11], v[22:23], s[78:79], v[10:11] op_sel:[0,1,0] op_sel_hi:[1,1,1]
    v_cvt_pk_bf16_f32 v24, v8, v10
    v_and_b32 v244, v24, v4
    v_and_b32 v245, v24, v5
    v_and_b32 v246, v24, v6
    v_and_b32 v247, v24, v7
    s_nop 1
    v_smfmac_f32_16x16x64_bf16 v[200:203], v[244:247], v[32:39], v252
    v_smfmac_f32_16x16x64_bf16 v[204:207], v[244:247], v[40:47], v252
    v_cvt_pk_bf16_f32 v25, v9, v11
    v_and_b32 v248, v25, v4
    v_and_b32 v249, v25, v5
    v_and_b32 v250, v25, v6
    v_and_b32 v251, v25, v7
    v_smfmac_f32_16x16x64_bf16 v[208:211], v[244:247], v[48:55], v252
    v_smfmac_f32_16x16x64_bf16 v[212:215], v[244:247], v[56:63], v252
    v_smfmac_f32_16x16x64_bf16 v[216:219], v[244:247], v[64:71], v252
    v_smfmac_f32_16x16x64_bf16 v[220:223], v[244:247], v[72:79], v252
    v_smfmac_f32_16x16x64_bf16 v[224:227], v[244:247], v[80:87], v252
    v_smfmac_f32_16x16x64_bf16 v[200:203], v[248:251], v[88:95], v252
    ds_read_b128 v[32:35], v253 offset:0
    ds_read_b128 v[36:39], v253 offset:1024
    v_smfmac_f32_16x16x64_bf16 v[204:207], v[248:251], v[96:103], v252
    ds_read_b128 v[40:43], v253 offset:2048
    ds_read_b128 v[44:47], v253 offset:3072
    v_smfmac_f32_16x16x64_bf16 v[208:211], v[248:251], v[104:111], v252
    ds_read_b128 v[48:51], v253 offset:4096
    ds_read_b128 v[52:55], v253 offset:5120
    v_smfmac_f32_16x16x64_bf16 v[212:215], v[248:251], v[112:119], v252
    ds_read_b128 v[56:59], v253 offset:6144
    ds_read_b128 v[60:63], v253 offset:7168
    v_smfmac_f32_16x16x64_bf16 v[216:219], v[248:251], v[120:127], v252
    ds_read_b128 v[64:67], v253 offset:8192
    ds_read_b128 v[68:71], v253 offset:9216
    v_smfmac_f32_16x16x64_bf16 v[220:223], v[248:251], v[128:135], v252
    ds_read_b128 v[72:75], v253 offset:10240
    ds_read_b128 v[76:79], v253 offset:11264
    v_smfmac_f32_16x16x64_bf16 v[224:227], v[248:251], v[136:143], v252
    ds_read_b128 v[80:83], v253 offset:12288
    ds_read_b128 v[84:87], v253 offset:13312
    s_waitcnt lgkmcnt(0)
    s_barrier
    ds_read_b64 v[8:9], v1 offset:12416
    ds_read_b64 v[10:11], v1 offset:12704
    ds_read_b64 v[12:13], v1 offset:13568
    ds_read_b64 v[14:15], v1 offset:13856
    ds_read_b64 v[16:17], v1 offset:14720
    ds_read_b64 v[18:19], v1 offset:15008
    ds_read_b64 v[20:21], v1 offset:15872
    ds_read_b64 v[22:23], v1 offset:16160
    s_waitcnt lgkmcnt(6)
    v_pk_mul_f32 v[8:9], v[8:9], s[76:77] op_sel:[0,0] op_sel_hi:[1,0]
    v_pk_mul_f32 v[10:11], v[10:11], s[76:77] op_sel:[0,0] op_sel_hi:[1,0]
    s_waitcnt lgkmcnt(4)
    v_pk_fma_f32 v[8:9], v[12:13], s[76:77], v[8:9] op_sel:[0,1,0] op_sel_hi:[1,1,1]
    v_pk_fma_f32 v[10:11], v[14:15], s[76:77], v[10:11] op_sel:[0,1,0] op_sel_hi:[1,1,1]
    s_waitcnt lgkmcnt(2)
    v_pk_fma_f32 v[8:9], v[16:17], s[78:79], v[8:9] op_sel:[0,0,0] op_sel_hi:[1,0,1]
    v_pk_fma_f32 v[10:11], v[18:19], s[78:79], v[10:11] op_sel:[0,0,0] op_sel_hi:[1,0,1]
    s_waitcnt lgkmcnt(0)
    v_pk_fma_f32 v[8:9], v[20:21], s[78:79], v[8:9] op_sel:[0,1,0] op_sel_hi:[1,1,1]
    v_pk_fma_f32 v[10:11], v[22:23], s[78:79], v[10:11] op_sel:[0,1,0] op_sel_hi:[1,1,1]
    v_cvt_pk_bf16_f32 v26, v8, v10
    v_and_b32 v244, v26, v4
    v_and_b32 v245, v26, v5
    v_and_b32 v246, v26, v6
    v_and_b32 v247, v26, v7
    s_nop 1
    v_smfmac_f32_16x16x64_bf16 v[216:219], v[244:247], v[176:183], v252
    v_cvt_pk_bf16_f32 v27, v9, v11
    v_and_b32 v248, v27, v4
    v_and_b32 v249, v27, v5
    v_and_b32 v250, v27, v6
    v_and_b32 v251, v27, v7
    v_smfmac_f32_16x16x64_bf16 v[200:203], v[244:247], v[144:151], v252
    v_smfmac_f32_16x16x64_bf16 v[220:223], v[244:247], v[184:191], v252
    v_smfmac_f32_16x16x64_bf16 v[216:219], v[248:251], v[64:71], v252
    v_smfmac_f32_16x16x64_bf16 v[200:203], v[248:251], v[32:39], v252
    s_nop 1
    v_smfmac_f32_16x16x64_bf16 v[220:223], v[248:251], v[72:79], v252
    s_nop 1
    v_smfmac_f32_16x16x64_bf16 v[204:207], v[244:247], v[152:159], v252
    s_nop 1
    v_smfmac_f32_16x16x64_bf16 v[204:207], v[248:251], v[40:47], v252
    v_cndmask_b32 v200, v200, v216, s[80:81]
    v_cndmask_b32 v201, v201, v217, s[80:81]
    v_smfmac_f32_16x16x64_bf16 v[224:227], v[244:247], v[192:199], v252
    v_cndmask_b32 v202, v202, v218, s[80:81]
    v_cndmask_b32 v203, v203, v219, s[80:81]
    v_smfmac_f32_16x16x64_bf16 v[224:227], v[248:251], v[80:87], v252
    ds_write_b128 v2, v[200:203] offset:16960
    v_smfmac_f32_16x16x64_bf16 v[208:211], v[244:247], v[160:167], v252
    s_nop 0
    v_smfmac_f32_16x16x64_bf16 v[208:211], v[248:251], v[48:55], v252
    v_cndmask_b32 v204, v204, v220, s[80:81]
    v_cndmask_b32 v205, v205, v221, s[80:81]
    v_smfmac_f32_16x16x64_bf16 v[212:215], v[244:247], v[168:175], v252
    v_cndmask_b32 v206, v206, v222, s[80:81]
    v_cndmask_b32 v207, v207, v223, s[80:81]
    v_smfmac_f32_16x16x64_bf16 v[212:215], v[248:251], v[56:63], v252
    ds_write_b128 v2, v[204:207] offset:17472
    s_nop 0
    v_cndmask_b32 v208, v208, v224, s[80:81]
    v_cndmask_b32 v209, v209, v225, s[80:81]
    v_cndmask_b32 v210, v210, v226, s[80:81]
    v_cndmask_b32 v211, v211, v227, s[80:81]
    ds_write_b128 v2, v[208:211] offset:17984
    s_mov_b32 exec_lo, 0x00ff00ff
    s_mov_b32 exec_hi, 0xff00ff00
    ds_write_b128 v31, v[212:215] offset:18496
    s_mov_b64 exec, -1
    s_waitcnt lgkmcnt(0)
    s_barrier
    ds_read2_b32 v[64:65], v3 offset0:0 offset1:1
    ds_read2_b32 v[66:67], v3 offset0:2 offset1:3
    ds_read2_b32 v[68:69], v3 offset0:4 offset1:5
    ds_read_b32 v70, v3 offset:24
    ds_read2_b32 v[72:73], v30 offset0:0 offset1:1
    ds_read2_b32 v[74:75], v30 offset0:2 offset1:3
    ds_read2_b32 v[76:77], v30 offset0:4 offset1:5
    ds_read_b32 v78, v30 offset:24
    s_waitcnt lgkmcnt(3)
    v_pk_add_f32 v[64:65], v[64:65], v[72:73]
    s_waitcnt lgkmcnt(2)
    v_pk_add_f32 v[66:67], v[66:67], v[74:75]
    s_waitcnt lgkmcnt(1)
    v_pk_add_f32 v[68:69], v[68:69], v[76:77]
    s_waitcnt lgkmcnt(0)
    v_add_f32 v70, v70, v78
    v_add_f32_dpp v64, v64, v64 quad_perm:[1,0,3,2] row_mask:0xf bank_mask:0xf
    v_add_f32_dpp v65, v65, v65 quad_perm:[1,0,3,2] row_mask:0xf bank_mask:0xf
    v_add_f32_dpp v66, v66, v66 quad_perm:[1,0,3,2] row_mask:0xf bank_mask:0xf
    v_add_f32_dpp v67, v67, v67 quad_perm:[1,0,3,2] row_mask:0xf bank_mask:0xf
    v_add_f32_dpp v68, v68, v68 quad_perm:[1,0,3,2] row_mask:0xf bank_mask:0xf
    v_add_f32_dpp v69, v69, v69 quad_perm:[1,0,3,2] row_mask:0xf bank_mask:0xf
    v_add_f32_dpp v70, v70, v70 quad_perm:[1,0,3,2] row_mask:0xf bank_mask:0xf
    v_add_f32_dpp v64, v64, v64 quad_perm:[2,3,0,1] row_mask:0xf bank_mask:0xf
    v_add_f32_dpp v65, v65, v65 quad_perm:[2,3,0,1] row_mask:0xf bank_mask:0xf
    v_add_f32_dpp v66, v66, v66 quad_perm:[2,3,0,1] row_mask:0xf bank_mask:0xf
    v_add_f32_dpp v67, v67, v67 quad_perm:[2,3,0,1] row_mask:0xf bank_mask:0xf
    v_add_f32_dpp v68, v68, v68 quad_perm:[2,3,0,1] row_mask:0xf bank_mask:0xf
    v_add_f32_dpp v69, v69, v69 quad_perm:[2,3,0,1] row_mask:0xf bank_mask:0xf
    v_add_f32_dpp v70, v70, v70 quad_perm:[2,3,0,1] row_mask:0xf bank_mask:0xf
    v_cvt_pk_bf16_f32 v72, v64, v65
    v_cvt_pk_bf16_f32 v73, v66, v67
    v_cvt_pk_bf16_f32 v74, v68, v69
    v_cvt_pk_bf16_f32 v75, v70, v70
    s_mov_b32 exec_lo, 0x11111111
    s_mov_b32 exec_hi, 0x11111111
    v_and_or_b32 v75, v75, v29, s43
    buffer_store_dwordx4 v[72:75], v28, s[56:59], s69 offen sc1
    s_cmp_lg_u32 s9, 0
    s_cbranch_scc1 L_kdone
    s_cmp_ge_u32 s8, 16
    s_cbranch_scc1 L_kdone
    s_mov_b64 exec, -1
    v_lshlrev_b32 v22, 4, v0
    v_mov_b32 v23, 0x40000000
    v_cmp_gt_u32 vcc, 32, v0
    v_mov_b32 v26, 0
    v_mov_b32 v27, s68
    v_cndmask_b32 v23, v23, v22, vcc
    v_cndmask_b32 v26, v26, v27, vcc
    v_lshlrev_b32 v21, 1, v255
    v_lshlrev_b32 v254, 16, v254
    s_lshl_b32 s69, s8, 12
    s_mov_b32 s71, 1048576
    v_lshlrev_b32 v25, 7, v0
    s_mov_b64 exec, 0xfffffff
    buffer_load_dword v24, v25, s[60:63], s69 offen
    s_mov_b64 exec, -1
    s_barrier
    s_barrier
    ds_read_b32 v60, v21 offset:41792
    s_waitcnt lgkmcnt(0)
    v_add_f32 v60, v60, v254
    buffer_load_dwordx4 v[80:83], v22, s[60:63], s69 offen offset:0 sc1
    buffer_load_dwordx4 v[84:87], v22, s[60:63], s69 offen offset:1024 sc1
    buffer_load_dwordx4 v[88:91], v22, s[60:63], s69 offen offset:2048 sc1
    buffer_load_dwordx4 v[92:95], v23, s[60:63], s69 offen offset:3072 sc1
    s_sleep 3
L_f:
    buffer_load_dwordx4 v[96:99], v22, s[60:63], s69 offen offset:0 sc1
    buffer_load_dwordx4 v[100:103], v22, s[60:63], s69 offen offset:1024 sc1
    buffer_load_dwordx4 v[104:107], v22, s[60:63], s69 offen offset:2048 sc1
    buffer_load_dwordx4 v[108:111], v23, s[60:63], s69 offen offset:3072 sc1
    s_waitcnt vmcnt(7)
    v_xor_b32 v80, s68, v80
    v_xor_b32 v81, s68, v81
    v_xor_b32 v82, s68, v82
    v_xor_b32 v83, s68, v83
    v_or3_b32 v28, v80, v81, v82
    v_or_b32 v28, v28, v83
    s_waitcnt vmcnt(6)
    v_xor_b32 v84, s68, v84
    v_xor_b32 v85, s68, v85
    v_xor_b32 v86, s68, v86
    v_xor_b32 v87, s68, v87
    v_or3_b32 v28, v28, v84, v85
    v_or3_b32 v28, v28, v86, v87
    s_waitcnt vmcnt(5)
    v_xor_b32 v88, s68, v88
    v_xor_b32 v89, s68, v89
    v_xor_b32 v90, s68, v90
    v_xor_b32 v91, s68, v91
    v_or3_b32 v28, v28, v88, v89
    v_or3_b32 v28, v28, v90, v91
    s_waitcnt vmcnt(4)
    v_xor_b32 v92, v26, v92
    v_xor_b32 v93, v26, v93
    v_xor_b32 v94, v26, v94
    v_xor_b32 v95, v26, v95
    v_or3_b32 v28, v28, v92, v93
    v_or3_b32 v28, v28, v94, v95
    v_and_b32 v28, 15, v28
    v_cmp_ne_u32 vcc, 0, v28
    s_cbranch_vccz L_fok0
    buffer_load_dwordx4 v[80:83], v22, s[60:63], s69 offen offset:0 sc1
    buffer_load_dwordx4 v[84:87], v22, s[60:63], s69 offen offset:1024 sc1
    buffer_load_dwordx4 v[88:91], v22, s[60:63], s69 offen offset:2048 sc1
    buffer_load_dwordx4 v[92:95], v23, s[60:63], s69 offen offset:3072 sc1
    s_waitcnt vmcnt(7)
    v_xor_b32 v96, s68, v96
    v_xor_b32 v97, s68, v97
    v_xor_b32 v98, s68, v98
    v_xor_b32 v99, s68, v99
    v_or3_b32 v28, v96, v97, v98
    v_or_b32 v28, v28, v99
    s_waitcnt vmcnt(6)
    v_xor_b32 v100, s68, v100
    v_xor_b32 v101, s68, v101
    v_xor_b32 v102, s68, v102
    v_xor_b32 v103, s68, v103
    v_or3_b32 v28, v28, v100, v101
    v_or3_b32 v28, v28, v102, v103
    s_waitcnt vmcnt(5)
    v_xor_b32 v104, s68, v104
    v_xor_b32 v105, s68, v105
    v_xor_b32 v106, s68, v106
    v_xor_b32 v107, s68, v107
    v_or3_b32 v28, v28, v104, v105
    v_or3_b32 v28, v28, v106, v107
    s_waitcnt vmcnt(4)
    v_xor_b32 v108, v26, v108
    v_xor_b32 v109, v26, v109
    v_xor_b32 v110, v26, v110
    v_xor_b32 v111, v26, v111
    v_or3_b32 v28, v28, v108, v109
    v_or3_b32 v28, v28, v110, v111
    v_and_b32 v28, 15, v28
    v_cmp_ne_u32 vcc, 0, v28
    s_cbranch_vccz L_fok1
    s_sub_u32 s71, s71, 1
    s_cmp_lg_u32 s71, 0
    s_cbranch_scc1 L_f
L_fok1:
    v_pk_add_f32 v[32:33], v[96:97], v[100:101]
    v_pk_add_f32 v[40:41], v[104:105], v[108:109]
    v_pk_add_f32 v[34:35], v[98:99], v[102:103]
    v_pk_add_f32 v[42:43], v[106:107], v[110:111]
    s_branch L_fok
L_fok0:
    v_pk_add_f32 v[32:33], v[80:81], v[84:85]
    v_pk_add_f32 v[40:41], v[88:89], v[92:93]
    v_pk_add_f32 v[34:35], v[82:83], v[86:87]
    v_pk_add_f32 v[42:43], v[90:91], v[94:95]
L_fok:
    v_pk_add_f32 v[32:33], v[32:33], v[40:41]
    v_pk_add_f32 v[34:35], v[34:35], v[42:43]
    s_nop 0
    v_add_f32_dpp v36, v32, v32 row_ror:8 row_mask:0xf bank_mask:0xf
    v_add_f32_dpp v37, v33, v33 row_ror:8 row_mask:0xf bank_mask:0xf
    v_add_f32_dpp v38, v34, v34 row_ror:8 row_mask:0xf bank_mask:0xf
    v_add_f32_dpp v39, v35, v35 row_ror:8 row_mask:0xf bank_mask:0xf
    s_nop 0
    v_permlane16_swap_b32 v36, v37
    v_permlane16_swap_b32 v38, v39
    v_add_f32 v32, v36, v37
    v_add_f32 v33, v38, v39
    s_nop 1
    v_permlane32_swap_b32 v32, v33
    v_add_f32 v32, v32, v33
    s_mov_b32 exec_lo, 0x007f007f
    s_mov_b32 exec_hi, 0x007f007f
    v_add_f32 v32, v32, v60
    v_cvt_pk_bf16_f32 v32, v32, v32
    buffer_store_short v32, v255, s[64:67], 0 offen
L_kdone:
    s_endpgm
L_vwave:
    s_add_u32 s70, s69, 16384
    s_bfe_u32 s6, s2, 0x10004
    s_and_b32 s8, s2, 31
    s_and_b32 s10, s2, 31
    v_lshrrev_b32 v24, 4, v0
    v_and_b32 v25, 15, v0
    s_cmp_lg_u32 s9, 0
    s_cbranch_scc1 L_qskip
    s_setprio 3
    v_lshrrev_b32 v21, 3, v0
    v_lshlrev_b32 v1, 13, v21
    v_and_b32 v20, 7, v0
    v_lshl_add_u32 v1, v20, 4, v1
    v_mul_u32_u24 v20, 896, v20
    v_lshl_add_u32 v26, v21, 4, v20
    v_lshl_add_u32 v27, v24, 4, v20
    s_lshl_b32 s74, s7, 1
    s_add_u32 s74, s74, s6
    s_and_b32 s14, s74, 3
    s_lshr_b32 s15, s74, 2
    s_lshl_b32 s12, s5, 2
    s_add_u32 s12, s12, s14
    s_lshl_b32 s12, s12, 7
    s_mul_i32 s73, s15, 917504
    s_mul_i32 s11, s15, 224
    s_lshl_b32 s71, s5, 7
    v_mov_b32 v29, s71
    s_mov_b32 m0, 46464
    s_waitcnt lgkmcnt(0)
    s_mov_b32 s52, s16
    s_mov_b32 s53, s17
    s_mov_b32 s54, 7168
    s_mov_b32 s55, 0x20000
    s_add_u32 s48, s22, s12
    s_addc_u32 s49, s23, 0
    s_mov_b32 s50, 3661952
    s_mov_b32 s51, 0x20000
    buffer_load_dwordx4 v[32:35], v26, s[52:55], 0 offen offset:0
    buffer_load_dwordx4 v[36:39], v26, s[52:55], 0 offen offset:128
    buffer_load_dwordx4 v[40:43], v26, s[52:55], 0 offen offset:256
    buffer_load_dwordx4 v[44:47], v26, s[52:55], 0 offen offset:384
    buffer_load_dwordx4 v[48:51], v26, s[52:55], 0 offen offset:512
    buffer_load_dwordx4 v[52:55], v26, s[52:55], 0 offen offset:640
    buffer_load_dwordx4 v[56:59], v26, s[52:55], 0 offen offset:768
    buffer_load_dwordx4 v[60:63], v27, s[52:55], s11 offen offset:0
    buffer_load_dwordx4 v[64:67], v27, s[52:55], s11 offen offset:64
    buffer_load_dwordx4 v[68:71], v27, s[52:55], s11 offen offset:128
    buffer_load_dwordx4 v[72:75], v27, s[52:55], s11 offen offset:192
    buffer_load_dwordx4 v1, s[48:51], s73 offen nt lds
    s_add_u32 s73, s73, 65536
    s_add_u32 m0, m0, 1024
    s_nop 0
    buffer_load_dwordx4 v1, s[48:51], s73 offen nt lds
    s_add_u32 s73, s73, 65536
    s_add_u32 m0, m0, 1024
    s_nop 0
    buffer_load_dwordx4 v1, s[48:51], s73 offen nt lds
    s_add_u32 s73, s73, 65536
    s_add_u32 m0, m0, 1024
    s_nop 0
    buffer_load_dwordx4 v1, s[48:51], s73 offen nt lds
    s_add_u32 s73, s73, 65536
    s_add_u32 m0, m0, 1024
    s_nop 0
    buffer_load_dwordx4 v1, s[48:51], s73 offen nt lds
    s_add_u32 s73, s73, 65536
    s_add_u32 m0, m0, 1024
    s_nop 0
    buffer_load_dwordx4 v1, s[48:51], s73 offen nt lds
    s_add_u32 s73, s73, 65536
    s_add_u32 m0, m0, 1024
    s_nop 0
    buffer_load_dwordx4 v1, s[48:51], s73 offen nt lds
    s_add_u32 s73, s73, 65536
    s_add_u32 m0, m0, 1024
    s_nop 0
    buffer_load_dwordx4 v1, s[48:51], s73 offen nt lds
    s_add_u32 s73, s73, 65536
    s_add_u32 m0, m0, 1024
    s_nop 0
    buffer_load_dwordx4 v1, s[48:51], s73 offen nt lds
    s_add_u32 s73, s73, 65536
    s_add_u32 m0, m0, 1024
    s_nop 0
    buffer_load_dwordx4 v1, s[48:51], s73 offen nt lds
    s_add_u32 s73, s73, 65536
    s_add_u32 m0, m0, 1024
    s_nop 0
    buffer_load_dwordx4 v1, s[48:51], s73 offen nt lds
    s_add_u32 s73, s73, 65536
    s_add_u32 m0, m0, 1024
    s_nop 0
    buffer_load_dwordx4 v1, s[48:51], s73 offen nt lds
    s_add_u32 s73, s73, 65536
    s_add_u32 m0, m0, 1024
    s_nop 0
    buffer_load_dwordx4 v1, s[48:51], s73 offen nt lds
    s_add_u32 s73, s73, 65536
    s_add_u32 m0, m0, 1024
    s_nop 0
    buffer_load_dwordx4 v1, s[48:51], s73 offen nt lds
    s_add_u32 s73, s73, 65536
    s_add_u32 m0, m0, 1024
    s_nop 0
    s_mov_b32 s73, 0x40000000
    buffer_load_dwordx4 v1, s[48:51], s73 offen nt lds
    s_add_u32 s73, s73, 65536
    s_add_u32 m0, m0, 1024
    s_nop 0
    buffer_load_dwordx4 v1, s[48:51], s73 offen nt lds
    s_add_u32 s73, s73, 65536
    s_add_u32 m0, m0, 1024
    global_load_dword v28, v29, s[40:41] offset:0 sc1
    v_lshrrev_b32 v20, 2, v25
    v_lshl_add_u32 v20, v24, 3, v20
    v_lshlrev_b32 v20, 7, v20
    v_and_b32 v21, 3, v0
    v_lshl_add_u32 v23, v21, 3, v20
    s_lshl_b32 s12, s5, 15
    s_add_u32 s12, s12, 8192
    s_add_u32 s60, s40, s12
    s_addc_u32 s61, s41, 0
    s_mov_b32 s62, 32768
    s_mov_b32 s63, 0x20000
    v_mov_b32 v20, 0x3f803f80
    v_mov_b32 v8, 0
    v_mov_b32 v9, 0
    v_mov_b32 v10, 0
    v_mov_b32 v11, 0
    s_waitcnt vmcnt(27)
    v_dot2c_f32_bf16 v8, v32, v20
    v_dot2c_f32_bf16 v10, v32, v32
    v_dot2c_f32_bf16 v9, v33, v20
    v_dot2c_f32_bf16 v11, v33, v33
    v_dot2c_f32_bf16 v8, v34, v20
    v_dot2c_f32_bf16 v10, v34, v34
    v_dot2c_f32_bf16 v9, v35, v20
    v_dot2c_f32_bf16 v11, v35, v35
    s_waitcnt vmcnt(26)
    v_dot2c_f32_bf16 v8, v36, v20
    v_dot2c_f32_bf16 v10, v36, v36
    v_dot2c_f32_bf16 v9, v37, v20
    v_dot2c_f32_bf16 v11, v37, v37
    v_dot2c_f32_bf16 v8, v38, v20
    v_dot2c_f32_bf16 v10, v38, v38
    v_dot2c_f32_bf16 v9, v39, v20
    v_dot2c_f32_bf16 v11, v39, v39
    s_waitcnt vmcnt(25)
    v_dot2c_f32_bf16 v8, v40, v20
    v_dot2c_f32_bf16 v10, v40, v40
    v_dot2c_f32_bf16 v9, v41, v20
    v_dot2c_f32_bf16 v11, v41, v41
    v_dot2c_f32_bf16 v8, v42, v20
    v_dot2c_f32_bf16 v10, v42, v42
    v_dot2c_f32_bf16 v9, v43, v20
    v_dot2c_f32_bf16 v11, v43, v43
    s_waitcnt vmcnt(24)
    v_dot2c_f32_bf16 v8, v44, v20
    v_dot2c_f32_bf16 v10, v44, v44
    v_dot2c_f32_bf16 v9, v45, v20
    v_dot2c_f32_bf16 v11, v45, v45
    v_dot2c_f32_bf16 v8, v46, v20
    v_dot2c_f32_bf16 v10, v46, v46
    v_dot2c_f32_bf16 v9, v47, v20
    v_dot2c_f32_bf16 v11, v47, v47
    s_waitcnt vmcnt(23)
    v_dot2c_f32_bf16 v8, v48, v20
    v_dot2c_f32_bf16 v10, v48, v48
    v_dot2c_f32_bf16 v9, v49, v20
    v_dot2c_f32_bf16 v11, v49, v49
    v_dot2c_f32_bf16 v8, v50, v20
    v_dot2c_f32_bf16 v10, v50, v50
    v_dot2c_f32_bf16 v9, v51, v20
    v_dot2c_f32_bf16 v11, v51, v51
    s_waitcnt vmcnt(22)
    v_dot2c_f32_bf16 v8, v52, v20
    v_dot2c_f32_bf16 v10, v52, v52
    v_dot2c_f32_bf16 v9, v53, v20
    v_dot2c_f32_bf16 v11, v53, v53
    v_dot2c_f32_bf16 v8, v54, v20
    v_dot2c_f32_bf16 v10, v54, v54
    v_dot2c_f32_bf16 v9, v55, v20
    v_dot2c_f32_bf16 v11, v55, v55
    s_waitcnt vmcnt(21)
    v_dot2c_f32_bf16 v8, v56, v20
    v_dot2c_f32_bf16 v10, v56, v56
    v_dot2c_f32_bf16 v9, v57, v20
    v_dot2c_f32_bf16 v11, v57, v57
    v_dot2c_f32_bf16 v8, v58, v20
    v_dot2c_f32_bf16 v10, v58, v58
    v_dot2c_f32_bf16 v9, v59, v20
    v_dot2c_f32_bf16 v11, v59, v59
    s_nop 2
    v_add_f32 v8, v8, v9
    v_add_f32 v10, v10, v11
    s_nop 0
    v_add_f32_dpp v8, v8, v8 row_ror:8 row_mask:0xf bank_mask:0xf
    v_add_f32_dpp v10, v10, v10 row_ror:8 row_mask:0xf bank_mask:0xf
    v_mov_b32 v9, v8
    v_mov_b32 v11, v10
    s_nop 0
    v_permlane16_swap_b32 v8, v9
    v_permlane16_swap_b32 v10, v11
    v_add_f32 v8, v8, v9
    v_add_f32 v10, v10, v11
    v_mov_b32 v9, v8
    v_mov_b32 v11, v10
    s_nop 0
    v_permlane32_swap_b32 v8, v9
    v_permlane32_swap_b32 v10, v11
    v_add_f32 v8, v8, v9
    v_add_f32 v10, v10, v11
    v_mul_f32 v30, 0x3b124925, v8
    v_mul_f32 v10, 0x3b124925, v10
    v_fma_f32 v10, -v30, v30, v10
    v_max_f32 v10, 0, v10
    v_cvt_pk_bf16_f32 v10, v30, v10
    v_lshlrev_b32 v30, 16, v10
    v_and_b32 v10, 0xffff0000, v10
    v_add_f32 v10, 0x3727c5ac, v10
    v_cvt_pk_bf16_f32 v10, v10, v10
    v_and_b32 v10, 0xffff0000, v10
    v_sqrt_f32 v10, v10
    s_nop 0
    v_cvt_pk_bf16_f32 v10, v10, v10
    v_and_b32 v10, 0xffff0000, v10
    v_rcp_f32 v31, v10
    s_waitcnt vmcnt(17)
    v_lshlrev_b32 v8, 16, v60
    v_and_b32 v9, 0xffff0000, v60
    v_sub_f32 v8, v8, v30
    v_sub_f32 v9, v9, v30
    v_cvt_pk_bf16_f32 v9, v8, v9
    v_lshlrev_b32 v8, 16, v9
    v_and_b32 v9, 0xffff0000, v9
    v_mul_f32 v8, v8, v31
    v_mul_f32 v9, v9, v31
    v_cvt_pk_bf16_f32 v60, v8, v9
    v_lshlrev_b32 v8, 16, v61
    v_and_b32 v9, 0xffff0000, v61
    v_sub_f32 v8, v8, v30
    v_sub_f32 v9, v9, v30
    v_cvt_pk_bf16_f32 v9, v8, v9
    v_lshlrev_b32 v8, 16, v9
    v_and_b32 v9, 0xffff0000, v9
    v_mul_f32 v8, v8, v31
    v_mul_f32 v9, v9, v31
    v_cvt_pk_bf16_f32 v61, v8, v9
    v_lshlrev_b32 v8, 16, v62
    v_and_b32 v9, 0xffff0000, v62
    v_sub_f32 v8, v8, v30
    v_sub_f32 v9, v9, v30
    v_cvt_pk_bf16_f32 v9, v8, v9
    v_lshlrev_b32 v8, 16, v9
    v_and_b32 v9, 0xffff0000, v9
    v_mul_f32 v8, v8, v31
    v_mul_f32 v9, v9, v31
    v_cvt_pk_bf16_f32 v62, v8, v9
    v_lshlrev_b32 v8, 16, v63
    v_and_b32 v9, 0xffff0000, v63
    v_sub_f32 v8, v8, v30
    v_sub_f32 v9, v9, v30
    v_cvt_pk_bf16_f32 v9, v8, v9
    v_lshlrev_b32 v8, 16, v9
    v_and_b32 v9, 0xffff0000, v9
    v_mul_f32 v8, v8, v31
    v_mul_f32 v9, v9, v31
    v_cvt_pk_bf16_f32 v63, v8, v9
    v_lshlrev_b32 v8, 16, v64
    v_and_b32 v9, 0xffff0000, v64
    v_sub_f32 v8, v8, v30
    v_sub_f32 v9, v9, v30
    v_cvt_pk_bf16_f32 v9, v8, v9
    v_lshlrev_b32 v8, 16, v9
    v_and_b32 v9, 0xffff0000, v9
    v_mul_f32 v8, v8, v31
    v_mul_f32 v9, v9, v31
    v_cvt_pk_bf16_f32 v64, v8, v9
    v_lshlrev_b32 v8, 16, v65
    v_and_b32 v9, 0xffff0000, v65
    v_sub_f32 v8, v8, v30
    v_sub_f32 v9, v9, v30
    v_cvt_pk_bf16_f32 v9, v8, v9
    v_lshlrev_b32 v8, 16, v9
    v_and_b32 v9, 0xffff0000, v9
    v_mul_f32 v8, v8, v31
    v_mul_f32 v9, v9, v31
    v_cvt_pk_bf16_f32 v65, v8, v9
    v_lshlrev_b32 v8, 16, v66
    v_and_b32 v9, 0xffff0000, v66
    v_sub_f32 v8, v8, v30
    v_sub_f32 v9, v9, v30
    v_cvt_pk_bf16_f32 v9, v8, v9
    v_lshlrev_b32 v8, 16, v9
    v_and_b32 v9, 0xffff0000, v9
    v_mul_f32 v8, v8, v31
    v_mul_f32 v9, v9, v31
    v_cvt_pk_bf16_f32 v66, v8, v9
    v_lshlrev_b32 v8, 16, v67
    v_and_b32 v9, 0xffff0000, v67
    v_sub_f32 v8, v8, v30
    v_sub_f32 v9, v9, v30
    v_cvt_pk_bf16_f32 v9, v8, v9
    v_lshlrev_b32 v8, 16, v9
    v_and_b32 v9, 0xffff0000, v9
    v_mul_f32 v8, v8, v31
    v_mul_f32 v9, v9, v31
    v_cvt_pk_bf16_f32 v67, v8, v9
    v_lshlrev_b32 v8, 16, v68
    v_and_b32 v9, 0xffff0000, v68
    v_sub_f32 v8, v8, v30
    v_sub_f32 v9, v9, v30
    v_cvt_pk_bf16_f32 v9, v8, v9
    v_lshlrev_b32 v8, 16, v9
    v_and_b32 v9, 0xffff0000, v9
    v_mul_f32 v8, v8, v31
    v_mul_f32 v9, v9, v31
    v_cvt_pk_bf16_f32 v68, v8, v9
    v_lshlrev_b32 v8, 16, v69
    v_and_b32 v9, 0xffff0000, v69
    v_sub_f32 v8, v8, v30
    v_sub_f32 v9, v9, v30
    v_cvt_pk_bf16_f32 v9, v8, v9
    v_lshlrev_b32 v8, 16, v9
    v_and_b32 v9, 0xffff0000, v9
    v_mul_f32 v8, v8, v31
    v_mul_f32 v9, v9, v31
    v_cvt_pk_bf16_f32 v69, v8, v9
    v_lshlrev_b32 v8, 16, v70
    v_and_b32 v9, 0xffff0000, v70
    v_sub_f32 v8, v8, v30
    v_sub_f32 v9, v9, v30
    v_cvt_pk_bf16_f32 v9, v8, v9
    v_lshlrev_b32 v8, 16, v9
    v_and_b32 v9, 0xffff0000, v9
    v_mul_f32 v8, v8, v31
    v_mul_f32 v9, v9, v31
    v_cvt_pk_bf16_f32 v70, v8, v9
    v_lshlrev_b32 v8, 16, v71
    v_and_b32 v9, 0xffff0000, v71
    v_sub_f32 v8, v8, v30
    v_sub_f32 v9, v9, v30
    v_cvt_pk_bf16_f32 v9, v8, v9
    v_lshlrev_b32 v8, 16, v9
    v_and_b32 v9, 0xffff0000, v9
    v_mul_f32 v8, v8, v31
    v_mul_f32 v9, v9, v31
    v_cvt_pk_bf16_f32 v71, v8, v9
    v_lshlrev_b32 v8, 16, v72
    v_and_b32 v9, 0xffff0000, v72
    v_sub_f32 v8, v8, v30
    v_sub_f32 v9, v9, v30
    v_cvt_pk_bf16_f32 v9, v8, v9
    v_lshlrev_b32 v8, 16, v9
    v_and_b32 v9, 0xffff0000, v9
    v_mul_f32 v8, v8, v31
    v_mul_f32 v9, v9, v31
    v_cvt_pk_bf16_f32 v72, v8, v9
    v_lshlrev_b32 v8, 16, v73
    v_and_b32 v9, 0xffff0000, v73
    v_sub_f32 v8, v8, v30
    v_sub_f32 v9, v9, v30
    v_cvt_pk_bf16_f32 v9, v8, v9
    v_lshlrev_b32 v8, 16, v9
    v_and_b32 v9, 0xffff0000, v9
    v_mul_f32 v8, v8, v31
    v_mul_f32 v9, v9, v31
    v_cvt_pk_bf16_f32 v73, v8, v9
    v_lshlrev_b32 v8, 16, v74
    v_and_b32 v9, 0xffff0000, v74
    v_sub_f32 v8, v8, v30
    v_sub_f32 v9, v9, v30
    v_cvt_pk_bf16_f32 v9, v8, v9
    v_lshlrev_b32 v8, 16, v9
    v_and_b32 v9, 0xffff0000, v9
    v_mul_f32 v8, v8, v31
    v_mul_f32 v9, v9, v31
    v_cvt_pk_bf16_f32 v74, v8, v9
    v_lshlrev_b32 v8, 16, v75
    v_and_b32 v9, 0xffff0000, v75
    v_sub_f32 v8, v8, v30
    v_sub_f32 v9, v9, v30
    v_cvt_pk_bf16_f32 v9, v8, v9
    v_lshlrev_b32 v8, 16, v9
    v_and_b32 v9, 0xffff0000, v9
    v_mul_f32 v8, v8, v31
    v_mul_f32 v9, v9, v31
    v_cvt_pk_bf16_f32 v75, v8, v9
    s_mov_b32 exec_lo, 0
    v_mov_b32 v72, 0
    v_mov_b32 v73, 0
    v_mov_b32 v74, 0
    v_mov_b32 v75, 0
    s_mov_b32 exec_lo, -1
    v_and_b32 v20, 7, v0
    v_lshlrev_b32 v20, 12, v20
    v_lshl_add_u32 v20, v24, 4, v20
    v_and_b32 v21, 8, v0
    v_lshl_add_u32 v20, v21, 3, v20
    s_lshl_b32 s15, s15, 10
    s_lshl_b32 s14, s14, 8
    s_add_u32 s14, s14, s15
    v_mov_b32 v21, 0xfffffff0
    v_lshlrev_b32 v22, 4, v0
    s_waitcnt vmcnt(0)
    v_readfirstlane_b32 s68, v28
    ds_read_b64_tr_b16 v[80:81], v23 offset:46464
    ds_read_b64_tr_b16 v[82:83], v23 offset:46976
    ds_read_b64_tr_b16 v[84:85], v23 offset:50560
    ds_read_b64_tr_b16 v[86:87], v23 offset:51072
    ds_read_b64_tr_b16 v[88:89], v23 offset:54656
    ds_read_b64_tr_b16 v[90:91], v23 offset:55168
    ds_read_b64_tr_b16 v[92:93], v23 offset:58752
    ds_read_b64_tr_b16 v[94:95], v23 offset:59264
    s_add_u32 s86, s68, 0x401
    s_and_b32 s68, s86, 15
    ds_read_b64_tr_b16 v[96:97], v23 offset:46496
    ds_read_b64_tr_b16 v[98:99], v23 offset:47008
    ds_read_b64_tr_b16 v[100:101], v23 offset:50592
    ds_read_b64_tr_b16 v[102:103], v23 offset:51104
    ds_read_b64_tr_b16 v[104:105], v23 offset:54688
    ds_read_b64_tr_b16 v[106:107], v23 offset:55200
    ds_read_b64_tr_b16 v[108:109], v23 offset:58784
    ds_read_b64_tr_b16 v[110:111], v23 offset:59296
    s_waitcnt lgkmcnt(8)
    v_mfma_f32_16x16x32_bf16 v[144:147], v[80:83], v[60:63], 0
    v_mfma_f32_16x16x32_bf16 v[144:147], v[84:87], v[64:67], v[144:147]
    v_mfma_f32_16x16x32_bf16 v[144:147], v[88:91], v[68:71], v[144:147]
    v_mfma_f32_16x16x32_bf16 v[144:147], v[92:95], v[72:75], v[144:147]
    ds_read_b64_tr_b16 v[112:113], v23 offset:46528
    ds_read_b64_tr_b16 v[114:115], v23 offset:47040
    ds_read_b64_tr_b16 v[116:117], v23 offset:50624
    ds_read_b64_tr_b16 v[118:119], v23 offset:51136
    ds_read_b64_tr_b16 v[120:121], v23 offset:54720
    ds_read_b64_tr_b16 v[122:123], v23 offset:55232
    ds_read_b64_tr_b16 v[124:125], v23 offset:58816
    ds_read_b64_tr_b16 v[126:127], v23 offset:59328
    s_waitcnt lgkmcnt(8)
    v_mfma_f32_16x16x32_bf16 v[148:151], v[96:99], v[60:63], 0
    v_mfma_f32_16x16x32_bf16 v[148:151], v[100:103], v[64:67], v[148:151]
    v_mfma_f32_16x16x32_bf16 v[148:151], v[104:107], v[68:71], v[148:151]
    v_mfma_f32_16x16x32_bf16 v[148:151], v[108:111], v[72:75], v[148:151]
    ds_read_b64_tr_b16 v[128:129], v23 offset:46560
    ds_read_b64_tr_b16 v[130:131], v23 offset:47072
    ds_read_b64_tr_b16 v[132:133], v23 offset:50656
    ds_read_b64_tr_b16 v[134:135], v23 offset:51168
    ds_read_b64_tr_b16 v[136:137], v23 offset:54752
    ds_read_b64_tr_b16 v[138:139], v23 offset:55264
    ds_read_b64_tr_b16 v[140:141], v23 offset:58848
    ds_read_b64_tr_b16 v[142:143], v23 offset:59360
    s_waitcnt lgkmcnt(8)
    v_mfma_f32_16x16x32_bf16 v[152:155], v[112:115], v[60:63], 0
    v_mfma_f32_16x16x32_bf16 v[152:155], v[116:119], v[64:67], v[152:155]
    v_mfma_f32_16x16x32_bf16 v[152:155], v[120:123], v[68:71], v[152:155]
    v_mfma_f32_16x16x32_bf16 v[152:155], v[124:127], v[72:75], v[152:155]
    s_waitcnt lgkmcnt(0)
    v_mfma_f32_16x16x32_bf16 v[156:159], v[128:131], v[60:63], 0
    v_mfma_f32_16x16x32_bf16 v[156:159], v[132:135], v[64:67], v[156:159]
    v_mfma_f32_16x16x32_bf16 v[156:159], v[136:139], v[68:71], v[156:159]
    v_mfma_f32_16x16x32_bf16 v[156:159], v[140:143], v[72:75], v[156:159]
    s_mov_b32 exec_lo, 0x00ff00ff
    s_mov_b32 exec_hi, 0x00ff00ff
    v_and_or_b32 v32, v144, v21, s68
    v_and_or_b32 v33, v145, v21, s68
    v_and_or_b32 v34, v146, v21, s68
    v_and_or_b32 v35, v147, v21, s68
    s_mov_b32 exec_lo, 0xff00ff00
    s_mov_b32 exec_hi, 0xff00ff00
    v_and_or_b32 v32, v148, v21, s68
    v_and_or_b32 v33, v149, v21, s68
    v_and_or_b32 v34, v150, v21, s68
    v_and_or_b32 v35, v151, v21, s68
    s_mov_b64 exec, -1
    buffer_store_dwordx4 v[32:35], v20, s[60:63], s14 offen offset:0 sc1
    s_mov_b32 exec_lo, 0x00ff00ff
    s_mov_b32 exec_hi, 0x00ff00ff
    v_and_or_b32 v36, v152, v21, s68
    v_and_or_b32 v37, v153, v21, s68
    v_and_or_b32 v38, v154, v21, s68
    v_and_or_b32 v39, v155, v21, s68
    s_mov_b32 exec_lo, 0xff00ff00
    s_mov_b32 exec_hi, 0xff00ff00
    v_and_or_b32 v36, v156, v21, s68
    v_and_or_b32 v37, v157, v21, s68
    v_and_or_b32 v38, v158, v21, s68
    v_and_or_b32 v39, v159, v21, s68
    s_mov_b64 exec, -1
    buffer_store_dwordx4 v[36:39], v20, s[60:63], s14 offen offset:128 sc1
    s_lshl_b32 s12, s7, 12
    s_mov_b32 s71, 1048576
    s_waitcnt vmcnt(0)
L_qpoll:
    buffer_load_dwordx4 v[80:83], v22, s[60:63], s12 offen offset:0 sc1
    buffer_load_dwordx4 v[84:87], v22, s[60:63], s12 offen offset:1024 sc1
    buffer_load_dwordx4 v[88:91], v22, s[60:63], s12 offen offset:2048 sc1
    buffer_load_dwordx4 v[92:95], v22, s[60:63], s12 offen offset:3072 sc1
    s_waitcnt vmcnt(3)
    v_xor_b32 v80, s68, v80
    v_xor_b32 v81, s68, v81
    v_xor_b32 v82, s68, v82
    v_xor_b32 v83, s68, v83
    v_or3_b32 v20, v80, v81, v82
    v_or_b32 v20, v20, v83
    s_waitcnt vmcnt(2)
    v_xor_b32 v84, s68, v84
    v_xor_b32 v85, s68, v85
    v_xor_b32 v86, s68, v86
    v_xor_b32 v87, s68, v87
    v_or3_b32 v20, v20, v84, v85
    v_or3_b32 v20, v20, v86, v87
    s_waitcnt vmcnt(1)
    v_xor_b32 v88, s68, v88
    v_xor_b32 v89, s68, v89
    v_xor_b32 v90, s68, v90
    v_xor_b32 v91, s68, v91
    v_or3_b32 v20, v20, v88, v89
    v_or3_b32 v20, v20, v90, v91
    s_waitcnt vmcnt(0)
    v_xor_b32 v92, s68, v92
    v_xor_b32 v93, s68, v93
    v_xor_b32 v94, s68, v94
    v_xor_b32 v95, s68, v95
    v_or3_b32 v20, v20, v92, v93
    v_or3_b32 v20, v20, v94, v95
    v_and_b32 v20, 15, v20
    v_cmp_ne_u32 vcc, 0, v20
    s_cbranch_vccz L_qok
    s_sleep 8
    s_sub_u32 s71, s71, 1
    s_cmp_lg_u32 s71, 0
    s_cbranch_scc1 L_qpoll
L_qok:
    v_pk_add_f32 v[80:81], v[80:81], v[84:85]
    v_pk_add_f32 v[88:89], v[88:89], v[92:93]
    v_pk_add_f32 v[82:83], v[82:83], v[86:87]
    v_pk_add_f32 v[90:91], v[90:91], v[94:95]
    v_pk_add_f32 v[80:81], v[80:81], v[88:89]
    v_pk_add_f32 v[82:83], v[82:83], v[90:91]
    v_cvt_pk_bf16_f32 v8, v80, v81
    v_cvt_pk_bf16_f32 v9, v82, v83
    v_lshlrev_b32 v20, 3, v0
    ds_write_b64 v20, v[8:9] offset:45888
    s_and_b32 s12, s86, 0xfffffc00
    v_mov_b32 v10, s12
    v_mov_b32 v11, 0
    ds_write_b32 v11, v10 offset:46420
    s_cmp_lg_u32 s74, 0
    s_cbranch_scc1 L_qskip
    v_mov_b32 v28, s86
    s_mov_b64 exec, 1
    global_store_dword v29, v28, s[40:41] offset:0 sc1
    s_mov_b64 exec, -1
L_qskip:
    s_waitcnt lgkmcnt(0)
    s_setprio 0
    s_barrier
    v_and_b32 v20, 1, v0
    v_lshlrev_b32 v20, 4, v20
    v_mov_b32 v21, 0xffff
    v_lshlrev_b32 v21, v20, v21
    v_bfe_u32 v20, v0, 1, 2
    v_cmp_eq_u32 vcc, 0, v20
    s_nop 1
    v_cndmask_b32 v4, 0, v21, vcc
    v_cmp_eq_u32 vcc, 1, v20
    s_nop 1
    v_cndmask_b32 v5, 0, v21, vcc
    v_cmp_eq_u32 vcc, 2, v20
    s_nop 1
    v_cndmask_b32 v6, 0, v21, vcc
    v_cmp_eq_u32 vcc, 3, v20
    s_nop 1
    v_cndmask_b32 v7, 0, v21, vcc
    s_mul_i32 s11, s7, 896
    s_add_u32 s52, s16, s11
    s_addc_u32 s53, s17, 0
    s_mov_b32 s54, 896
    s_mov_b32 s55, 0x20000
    v_mov_b32 v231, 0x40000000
    s_lshl_b32 s12, s7, 16
    s_add_u32 s11, s12, 532480
    s_add_u32 s56, s40, s11
    s_addc_u32 s57, s41, 0
    s_mov_b32 s58, 65536
    s_mov_b32 s59, 0x20000
    s_lshl_b32 s12, s5, 7
    s_add_u32 s12, s12, 4096
    v_and_b32 v13, 15, v0
    v_lshl_add_u32 v13, v13, 2, s12
    s_lshl_b32 s11, s7, 1
    s_add_u32 s11, s11, s6
    s_lshl_b32 s11, s11, 2
    s_add_u32 s12, s12, s11
    v_mov_b32 v12, s12
    v_and_b32 v14, 31, v0
    v_lshlrev_b32 v14, 11, v14
    v_mov_b32 v15, 0
    ds_read_b32 v8, v15 offset:46420
    s_mov_b32 s84, 0
    s_mov_b32 s82, -16
    s_getreg_b32 s11, hwreg(HW_REG_XCC_ID, 0, 1)
    s_mul_i32 s11, s11, 32
    s_sub_i32 s11, s11, 16
    s_add_i32 s82, s82, s11
    s_mov_b32 s83, s82
    s_mov_b32 s85, 100000
    s_waitcnt lgkmcnt(0)
    v_readfirstlane_b32 s86, v8
    s_cmp_ge_u32 s8, 28
    s_cbranch_scc1 L_nomlpw_114
    s_mov_b32 s48, s28
    s_mov_b32 s49, s29
    s_mov_b32 s50, 1605632
    s_mov_b32 s51, 0x20000
    s_lshl_b32 s12, s7, 2
    s_add_u32 s12, s12, s9
    s_mul_i32 s12, s12, 50176
    s_lshl_b32 s11, s8, 7
    s_add_u32 s12, s12, s11
    v_mul_u32_u24 v20, 3584, v0
    s_mov_b64 exec, 0x3fff
    buffer_load_dword v29, v20, s[48:51], s12 offen
    s_mov_b64 exec, -1
    s_mov_b32 s48, s32
    s_mov_b32 s49, s33
    s_mov_b32 s50, 1605632
    s_mov_b32 s51, 0x20000
    s_lshl_b32 s12, s8, 3
    s_add_u32 s12, s12, s7
    s_lshl_b32 s12, s12, 2
    s_add_u32 s12, s12, s9
    s_mul_i32 s12, s12, 1792
    v_lshlrev_b32 v20, 6, v0
    s_mov_b64 exec, 0xfffffff
    buffer_load_dword v28, v20, s[48:51], s12 offen
    s_mov_b64 exec, -1
    v_mul_u32_u24 v20, 14, v0
    buffer_load_ushort v216, v20, s[52:55], 0 offen offset:0
    buffer_load_ushort v217, v20, s[52:55], 0 offen offset:2
    buffer_load_ushort v218, v20, s[52:55], 0 offen offset:4
    buffer_load_ushort v219, v20, s[52:55], 0 offen offset:6
    buffer_load_ushort v220, v20, s[52:55], 0 offen offset:8
    buffer_load_ushort v221, v20, s[52:55], 0 offen offset:10
    buffer_load_ushort v222, v20, s[52:55], 0 offen offset:12
    v_mul_u32_u24 v223, 28, v0
    v_and_b32 v20, 1, v24
    v_lshlrev_b32 v20, 5, v20
    v_lshrrev_b32 v21, 1, v24
    v_lshl_add_u32 v20, v21, 3, v20
    v_and_b32 v21, 8, v0
    v_lshl_add_u32 v20, v21, 1, v20
    v_and_b32 v21, 7, v0
    v_add_u32 v20, v20, v21
    v_lshlrev_b32 v230, 2, v20
    v_add_u32 v230, 43840, v230
    v_lshlrev_b32 v20, 1, v20
    s_lshl_b32 s12, s8, 7
    s_add_u32 s52, s30, s12
    s_addc_u32 s53, s31, 0
    s_mov_b32 s54, 128
    s_mov_b32 s55, 0x20000
    buffer_load_ushort v224, v20, s[52:55], 0 offen
    v_mov_b32 v22, 0xffff
    v_and_b32 v23, 4, v0
    v_cmp_eq_u32 vcc, 0, v23
    v_and_b32 v227, 3, v0
    v_mul_u32_u24 v227, 0x5555, v227
    v_cndmask_b32 v225, 0, v22, vcc
    v_xor_b32 v226, v225, v22
    v_lshlrev_b32 v225, 16, v225
    v_lshlrev_b32 v226, 16, v226
    v_bfe_u32 v20, v0, 3, 1
    v_lshl_add_u32 v20, v24, 2, v20
    s_mul_i32 s12, s9, 448
    s_add_u32 s12, s12, 41792
    v_lshl_add_u32 v228, v20, 2, s12
    v_lshlrev_b32 v20, 5, v21
    v_and_b32 v22, 1, v24
    v_lshl_add_u32 v20, v22, 4, v20
    v_lshrrev_b32 v23, 1, v24
    v_lshl_add_u32 v20, v23, 8, v20
    s_lshl_b32 s12, s9, 9
    v_add_u32 v229, s12, v20
    v_lshl_add_u32 v20, v25, 1, v22
    v_mul_u32_u24 v22, 37, v20
    v_lshrrev_b32 v22, 8, v22
    v_mul_u32_u24 v23, 7, v22
    v_sub_u32 v20, v20, v23
    v_cmp_gt_u32 vcc, 32, v0
    v_mov_b32 v23, 7
    s_nop 0
    v_cndmask_b32 v20, v23, v20, vcc
    v_cndmask_b32 v22, v25, v22, vcc
    v_lshlrev_b32 v22, 12, v22
    v_lshl_add_u32 v231, v20, 4, v22
    s_waitcnt vmcnt(0)
    v_lshlrev_b32 v216, 16, v216
    v_lshlrev_b32 v217, 16, v217
    v_lshlrev_b32 v218, 16, v218
    v_lshlrev_b32 v219, 16, v219
    v_lshlrev_b32 v220, 16, v220
    v_lshlrev_b32 v221, 16, v221
    v_lshlrev_b32 v222, 16, v222
    v_lshlrev_b32 v224, 16, v224
    s_mul_i32 s12, s8, 57344
    s_mul_i32 s11, s9, 224
    s_add_u32 s73, s12, s11
    s_mov_b32 s48, s32
    s_mov_b32 s49, s33
    s_mov_b32 s50, 1605632
    s_mov_b32 s51, 0x20000
    v_mul_u32_u24 v20, 14336, v24
    v_lshl_add_u32 v20, v25, 4, v20
    v_mov_b32 v21, 0x40000000
    v_cmp_gt_u32 vcc, 14, v25
    s_nop 1
    v_cndmask_b32 v20, v21, v20, vcc
    s_cmp_lg_u32 s9, 3
    s_cbranch_scc1 L_nm_115
    s_call_b64 s[14:15], L_mon
L_nm_115:
    s_waitcnt vmcnt(1)
    buffer_load_dwordx4 v[152:155], v20, s[48:51], s73 offen
    s_add_u32 s73, s73, 896
    s_waitcnt vmcnt(1)
    buffer_load_dwordx4 v[160:163], v20, s[48:51], s73 offen
    s_add_u32 s73, s73, 896
    s_cmp_lg_u32 s9, 3
    s_cbranch_scc1 L_nm_116
    s_call_b64 s[14:15], L_mon
L_nm_116:
    s_waitcnt vmcnt(1)
    buffer_load_dwordx4 v[168:171], v20, s[48:51], s73 offen
    s_add_u32 s73, s73, 896
    s_waitcnt vmcnt(1)
    buffer_load_dwordx4 v[176:179], v20, s[48:51], s73 offen
    s_add_u32 s73, s73, 896
    s_cmp_lg_u32 s9, 3
    s_cbranch_scc1 L_nm_117
    s_call_b64 s[14:15], L_mon
L_nm_117:
    s_waitcnt vmcnt(1)
    buffer_load_dwordx4 v[184:187], v20, s[48:51], s73 offen
    s_add_u32 s73, s73, 896
    s_waitcnt vmcnt(1)
    buffer_load_dwordx4 v[192:195], v20, s[48:51], s73 offen
    s_add_u32 s73, s73, 896
    s_cmp_lg_u32 s9, 3
    s_cbranch_scc1 L_nm_118
    s_call_b64 s[14:15], L_mon
L_nm_118:
    s_waitcnt vmcnt(1)
    buffer_load_dwordx4 v[200:203], v20, s[48:51], s73 offen
    s_add_u32 s73, s73, 896
    s_waitcnt vmcnt(1)
    buffer_load_dwordx4 v[208:211], v20, s[48:51], s73 offen
    s_add_u32 s73, s73, 896
    s_cmp_lg_u32 s9, 3
    s_cbranch_scc1 L_nm_119
    s_call_b64 s[14:15], L_mon
L_nm_119:
    s_waitcnt vmcnt(1)
    buffer_load_dwordx4 v[156:159], v20, s[48:51], s73 offen
    s_add_u32 s73, s73, 896
    s_waitcnt vmcnt(1)
    buffer_load_dwordx4 v[164:167], v20, s[48:51], s73 offen
    s_add_u32 s73, s73, 896
    s_cmp_lg_u32 s9, 3
    s_cbranch_scc1 L_nm_120
    s_call_b64 s[14:15], L_mon
L_nm_120:
    s_waitcnt vmcnt(1)
    buffer_load_dwordx4 v[172:175], v20, s[48:51], s73 offen
    s_add_u32 s73, s73, 896
    s_waitcnt vmcnt(1)
    buffer_load_dwordx4 v[180:183], v20, s[48:51], s73 offen
    s_add_u32 s73, s73, 896
    s_cmp_lg_u32 s9, 3
    s_cbranch_scc1 L_nm_121
    s_call_b64 s[14:15], L_mon
L_nm_121:
    s_waitcnt vmcnt(1)
    buffer_load_dwordx4 v[188:191], v20, s[48:51], s73 offen
    s_add_u32 s73, s73, 896
    s_waitcnt vmcnt(1)
    buffer_load_dwordx4 v[196:199], v20, s[48:51], s73 offen
    s_add_u32 s73, s73, 896
    s_cmp_lg_u32 s9, 3
    s_cbranch_scc1 L_nm_122
    s_call_b64 s[14:15], L_mon
L_nm_122:
    s_waitcnt vmcnt(1)
    buffer_load_dwordx4 v[204:207], v20, s[48:51], s73 offen
    s_add_u32 s73, s73, 896
    s_waitcnt vmcnt(1)
    buffer_load_dwordx4 v[212:215], v20, s[48:51], s73 offen
    s_add_u32 s73, s73, 896
    s_mul_i32 s12, s9, 401408
    s_lshl_b32 s11, s8, 7
    s_add_u32 s73, s12, s11
    s_mov_b32 s48, s28
    s_mov_b32 s49, s29
    s_mov_b32 s50, 1605632
    s_mov_b32 s51, 0x20000
    v_lshrrev_b32 v20, 3, v0
    v_mul_u32_u24 v20, 3584, v20
    v_and_b32 v21, 7, v0
    v_lshl_add_u32 v20, v21, 4, v20
    s_cmp_lg_u32 s9, 3
    s_cbranch_scc1 L_nm_123
    s_call_b64 s[14:15], L_mon
L_nm_123:
    s_waitcnt vmcnt(1)
    buffer_load_dwordx4 v[96:99], v20, s[48:51], s73 offen
    s_add_u32 s73, s73, 28672
    s_waitcnt vmcnt(1)
    buffer_load_dwordx4 v[100:103], v20, s[48:51], s73 offen
    s_add_u32 s73, s73, 28672
    s_cmp_lg_u32 s9, 3
    s_cbranch_scc1 L_nm_124
    s_call_b64 s[14:15], L_mon
L_nm_124:
    s_waitcnt vmcnt(1)
    buffer_load_dwordx4 v[104:107], v20, s[48:51], s73 offen
    s_add_u32 s73, s73, 28672
    s_waitcnt vmcnt(1)
    buffer_load_dwordx4 v[108:111], v20, s[48:51], s73 offen
    s_add_u32 s73, s73, 28672
    s_cmp_lg_u32 s9, 3
    s_cbranch_scc1 L_nm_125
    s_call_b64 s[14:15], L_mon
L_nm_125:
    s_waitcnt vmcnt(1)
    buffer_load_dwordx4 v[112:115], v20, s[48:51], s73 offen
    s_add_u32 s73, s73, 28672
    s_waitcnt vmcnt(1)
    buffer_load_dwordx4 v[116:119], v20, s[48:51], s73 offen
    s_add_u32 s73, s73, 28672
    s_cmp_lg_u32 s9, 3
    s_cbranch_scc1 L_nm_126
    s_call_b64 s[14:15], L_mon
L_nm_126:
    s_waitcnt vmcnt(1)
    buffer_load_dwordx4 v[120:123], v20, s[48:51], s73 offen
    s_add_u32 s73, s73, 28672
    s_waitcnt vmcnt(1)
    buffer_load_dwordx4 v[124:127], v20, s[48:51], s73 offen
    s_add_u32 s73, s73, 28672
    s_cmp_lg_u32 s9, 3
    s_cbranch_scc1 L_nm_127
    s_call_b64 s[14:15], L_mon
L_nm_127:
    s_waitcnt vmcnt(1)
    buffer_load_dwordx4 v[128:131], v20, s[48:51], s73 offen
    s_add_u32 s73, s73, 28672
    s_waitcnt vmcnt(1)
    buffer_load_dwordx4 v[132:135], v20, s[48:51], s73 offen
    s_add_u32 s73, s73, 28672
    s_cmp_lg_u32 s9, 3
    s_cbranch_scc1 L_nm_128
    s_call_b64 s[14:15], L_mon
L_nm_128:
    s_waitcnt vmcnt(1)
    buffer_load_dwordx4 v[136:139], v20, s[48:51], s73 offen
    s_add_u32 s73, s73, 28672
    s_waitcnt vmcnt(1)
    buffer_load_dwordx4 v[140:143], v20, s[48:51], s73 offen
    s_add_u32 s73, s73, 28672
    s_cmp_lg_u32 s9, 3
    s_cbranch_scc1 L_nm_129
    s_call_b64 s[14:15], L_mon
L_nm_129:
    s_waitcnt vmcnt(1)
    buffer_load_dwordx4 v[144:147], v20, s[48:51], s73 offen
    s_add_u32 s73, s73, 28672
    s_waitcnt vmcnt(1)
    buffer_load_dwordx4 v[148:151], v20, s[48:51], s73 offen
    s_add_u32 s73, s73, 28672
    v_add_u32 v223, 41792, v223
    v_and_b32 v20, 0x3f800000, v225
    v_mov_b32 v16, 0
    v_and_b32 v21, 0x3f800000, v226
    v_mov_b32 v17, 0
    v_and_b32 v22, 0x3f800000, v225
    v_mov_b32 v18, 0
    v_and_b32 v23, 0x3f800000, v226
    v_mov_b32 v19, 0
    s_waitcnt vmcnt(0)
    s_nop 0
    v_smfmac_f32_16x16x64_bf16 v[16:19], v[20:23], v[96:103], v227
    v_smfmac_f32_16x16x64_bf16 v[16:19], v[20:23], v[104:111], v227
    v_smfmac_f32_16x16x64_bf16 v[16:19], v[20:23], v[112:119], v227
    v_smfmac_f32_16x16x64_bf16 v[16:19], v[20:23], v[120:127], v227
    v_smfmac_f32_16x16x64_bf16 v[16:19], v[20:23], v[128:135], v227
    v_smfmac_f32_16x16x64_bf16 v[16:19], v[20:23], v[136:143], v227
    v_smfmac_f32_16x16x64_bf16 v[16:19], v[20:23], v[144:151], v227
    s_mov_b32 exec_lo, 0x00ff00ff
    s_mov_b32 exec_hi, 0xff00ff00
    s_nop 5
    ds_write_b128 v229, v[16:19] offset:2048
    s_mov_b64 exec, -1
    s_waitcnt lgkmcnt(0)
L_nomlpw_114:
    s_lshl_b32 s12, s7, 7
    v_mov_b32 v21, s12
    global_load_dword v20, v21, s[40:41] offset:2048 sc1
    s_waitcnt vmcnt(0)
    v_readfirstlane_b32 s68, v20
    s_nop 0
    s_add_u32 s42, s68, 0x10001
    s_and_b32 s68, s42, 15
    s_and_b32 s43, s42, 0xffff0000
    s_lshl_b32 s12, s7, 16
    s_add_u32 s11, s12, 532480
    s_add_u32 s56, s40, s11
    s_addc_u32 s57, s41, 0
    s_mov_b32 s58, 65536
    s_mov_b32 s59, 0x20000
    s_add_u32 s11, s12, 1056768
    s_add_u32 s60, s40, s11
    s_addc_u32 s61, s41, 0
    s_mov_b32 s62, 65536
    s_mov_b32 s63, 0x20000
    s_add_u32 s44, s20, s13
    s_addc_u32 s45, s21, 0
    s_mov_b32 s46, 2097152
    s_mov_b32 s47, 0x20000
    buffer_load_dword v28, off, s[44:47], s69 nt
    s_waitcnt vmcnt(0)
    v_lshlrev_b32 v1, 9, v24
    v_lshl_add_u32 v1, v25, 4, v1
    s_lshl_b32 s12, s9, 11
    v_lshl_add_u32 v20, v0, 2, s12
    v_lshl_add_u32 v232, v0, 4, s12
    v_and_b32 v21, 7, v0
    v_mul_u32_u24 v21, 144, v21
    v_lshl_add_u32 v21, v24, 4, v21
    s_mul_i32 s12, s9, 1152
    v_add_u32 v21, s12, v21
    v_lshlrev_b32 v22, 4, v0
    v_mov_b32 v31, 0xfffffff0
    s_lshl_b32 s12, s9, 2
    v_mov_b32 v233, s12
    v_mov_b32 v235, 0
    v_mov_b32 v234, 0
    s_mov_b32 s76, 64
    s_cmp_lg_u32 s9, 3
    s_cbranch_scc1 L_nm_130
    s_mov_b32 s71, 1048576
L_ml_131:
    s_call_b64 s[14:15], L_mon
    s_cmp_ge_u32 s87, 240
    s_cbranch_scc1 L_nm_130
    s_sleep 12
    s_sub_u32 s71, s71, 1
    s_cmp_lg_u32 s71, 0
    s_cbranch_scc1 L_ml_131
L_nm_130:
    s_mov_b64 vcc, 0
    s_lshl_b32 s75, s9, 14
    s_lshl_b32 s12, s8, 7
    s_add_u32 s75, s75, s12
    s_barrier
    buffer_load_dwordx4 v[32:35], v1, s[44:47], s69 offen offset:0 nt
    buffer_load_dwordx4 v[36:39], v1, s[44:47], s69 offen offset:256 nt
    s_add_u32 s76, s76, 1
    v_mov_b32 v29, s76
    ds_write_b32 v233, v29 offset:46400
    buffer_load_dwordx4 v[40:43], v1, s[44:47], s69 offen offset:2048 nt
    buffer_load_dwordx4 v[44:47], v1, s[44:47], s69 offen offset:2304 nt
    buffer_load_dwordx4 v[48:51], v1, s[44:47], s70 offen offset:0 nt
    s_waitcnt vmcnt(4)
    buffer_load_dwordx4 v[52:55], v1, s[44:47], s70 offen offset:256 nt
    s_add_u32 s76, s76, 1
    v_mov_b32 v29, s76
    ds_write_b32 v233, v29 offset:46400
    s_waitcnt vmcnt(4)
    buffer_load_dwordx4 v[56:59], v1, s[44:47], s70 offen offset:2048 nt
    s_waitcnt vmcnt(4)
    buffer_load_dwordx4 v[60:63], v1, s[44:47], s70 offen offset:2304 nt
    s_add_u32 s69, s69, 65536
    s_add_u32 s70, s70, 65536
    s_waitcnt vmcnt(4)
    buffer_load_dwordx4 v[64:67], v1, s[44:47], s69 offen offset:0 nt
    s_waitcnt vmcnt(4)
    buffer_load_dwordx4 v[68:71], v1, s[44:47], s69 offen offset:256 nt
    s_add_u32 s76, s76, 1
    v_mov_b32 v29, s76
    ds_write_b32 v233, v29 offset:46400
    s_waitcnt vmcnt(4)
    buffer_load_dwordx4 v[72:75], v1, s[44:47], s69 offen offset:2048 nt
    s_waitcnt vmcnt(4)
    buffer_load_dwordx4 v[76:79], v1, s[44:47], s69 offen offset:2304 nt
    s_waitcnt vmcnt(4)
    buffer_load_dwordx4 v[80:83], v1, s[44:47], s70 offen offset:0 nt
    s_waitcnt vmcnt(4)
    buffer_load_dwordx4 v[84:87], v1, s[44:47], s70 offen offset:256 nt
    s_add_u32 s76, s76, 1
    v_mov_b32 v29, s76
    ds_write_b32 v233, v29 offset:46400
    s_waitcnt vmcnt(4)
    buffer_load_dwordx4 v[88:91], v1, s[44:47], s70 offen offset:2048 nt
    s_waitcnt vmcnt(4)
    buffer_load_dwordx4 v[92:95], v1, s[44:47], s70 offen offset:2304 nt
    s_add_u32 s69, s69, 65536
    s_add_u32 s70, s70, 65536
    s_barrier
    ds_read_b32 v2, v20 offset:4096
    ds_read_b32 v3, v20 offset:4352
    v_add_u32 v20, 512, v20
    s_waitcnt lgkmcnt(0)
    v_and_b32_dpp v16, v2, v4 row_newbcast:0 row_mask:0xf bank_mask:0xf
    v_and_b32_dpp v17, v2, v5 row_newbcast:0 row_mask:0xf bank_mask:0xf
    v_and_b32_dpp v18, v2, v6 row_newbcast:0 row_mask:0xf bank_mask:0xf
    v_and_b32_dpp v19, v2, v7 row_newbcast:0 row_mask:0xf bank_mask:0xf
    s_nop 1
    v_mfma_f32_16x16x32_bf16 v[8:11], v[32:35], v[16:19], 0
    s_waitcnt vmcnt(5)
    s_cbranch_vccnz L_w_132
    s_waitcnt vmcnt(4)
L_w_132:
    buffer_load_dwordx4 v[32:35], v1, s[44:47], s69 offen offset:0 nt
    v_mfma_f32_16x16x32_bf16 v[12:15], v[36:39], v[16:19], 0
    v_and_b32_dpp v16, v2, v4 row_newbcast:4 row_mask:0xf bank_mask:0xf
    v_and_b32_dpp v17, v2, v5 row_newbcast:4 row_mask:0xf bank_mask:0xf
    v_and_b32_dpp v18, v2, v6 row_newbcast:4 row_mask:0xf bank_mask:0xf
    v_and_b32_dpp v19, v2, v7 row_newbcast:4 row_mask:0xf bank_mask:0xf
    s_nop 1
    v_mfma_f32_16x16x32_bf16 v[8:11], v[40:43], v[16:19], v[8:11]
    s_waitcnt vmcnt(5)
    s_cbranch_vccnz L_w_133
    s_waitcnt vmcnt(4)
L_w_133:
    buffer_load_dwordx4 v[36:39], v1, s[44:47], s69 offen offset:256 nt
    s_add_u32 s76, s76, 1
    s_waitcnt lgkmcnt(0)
    v_readfirstlane_b32 s12, v234
    v_mov_b32 v29, s76
    ds_write_b32 v233, v29 offset:46400
    ds_read_b32 v234, v235 offset:46416
    s_cmp_lt_u32 s76, s12
    s_cselect_b64 vcc, -1, 0
    v_mfma_f32_16x16x32_bf16 v[12:15], v[44:47], v[16:19], v[12:15]
    v_and_b32_dpp v16, v2, v4 row_newbcast:8 row_mask:0xf bank_mask:0xf
    v_and_b32_dpp v17, v2, v5 row_newbcast:8 row_mask:0xf bank_mask:0xf
    v_and_b32_dpp v18, v2, v6 row_newbcast:8 row_mask:0xf bank_mask:0xf
    v_and_b32_dpp v19, v2, v7 row_newbcast:8 row_mask:0xf bank_mask:0xf
    s_nop 1
    v_mfma_f32_16x16x32_bf16 v[8:11], v[48:51], v[16:19], v[8:11]
    s_waitcnt vmcnt(5)
    s_cbranch_vccnz L_w_134
    s_waitcnt vmcnt(4)
L_w_134:
    buffer_load_dwordx4 v[40:43], v1, s[44:47], s69 offen offset:2048 nt
    v_mfma_f32_16x16x32_bf16 v[12:15], v[52:55], v[16:19], v[12:15]
    v_and_b32_dpp v16, v2, v4 row_newbcast:12 row_mask:0xf bank_mask:0xf
    v_and_b32_dpp v17, v2, v5 row_newbcast:12 row_mask:0xf bank_mask:0xf
    v_and_b32_dpp v18, v2, v6 row_newbcast:12 row_mask:0xf bank_mask:0xf
    v_and_b32_dpp v19, v2, v7 row_newbcast:12 row_mask:0xf bank_mask:0xf
    s_nop 1
    v_mfma_f32_16x16x32_bf16 v[8:11], v[56:59], v[16:19], v[8:11]
    s_waitcnt vmcnt(5)
    s_cbranch_vccnz L_w_135
    s_waitcnt vmcnt(4)
L_w_135:
    buffer_load_dwordx4 v[44:47], v1, s[44:47], s69 offen offset:2304 nt
    v_mfma_f32_16x16x32_bf16 v[12:15], v[60:63], v[16:19], v[12:15]
    v_and_b32_dpp v16, v2, v4 row_newbcast:1 row_mask:0xf bank_mask:0xf
    v_and_b32_dpp v17, v2, v5 row_newbcast:1 row_mask:0xf bank_mask:0xf
    v_and_b32_dpp v18, v2, v6 row_newbcast:1 row_mask:0xf bank_mask:0xf
    v_and_b32_dpp v19, v2, v7 row_newbcast:1 row_mask:0xf bank_mask:0xf
    s_nop 1
    v_mfma_f32_16x16x32_bf16 v[8:11], v[64:67], v[16:19], v[8:11]
    s_waitcnt vmcnt(5)
    s_cbranch_vccnz L_w_136
    s_waitcnt vmcnt(4)
L_w_136:
    buffer_load_dwordx4 v[48:51], v1, s[44:47], s70 offen offset:0 nt
    v_mfma_f32_16x16x32_bf16 v[12:15], v[68:71], v[16:19], v[12:15]
    v_and_b32_dpp v16, v2, v4 row_newbcast:5 row_mask:0xf bank_mask:0xf
    v_and_b32_dpp v17, v2, v5 row_newbcast:5 row_mask:0xf bank_mask:0xf
    v_and_b32_dpp v18, v2, v6 row_newbcast:5 row_mask:0xf bank_mask:0xf
    v_and_b32_dpp v19, v2, v7 row_newbcast:5 row_mask:0xf bank_mask:0xf
    s_nop 1
    v_mfma_f32_16x16x32_bf16 v[8:11], v[72:75], v[16:19], v[8:11]
    s_waitcnt vmcnt(5)
    s_cbranch_vccnz L_w_137
    s_waitcnt vmcnt(4)
L_w_137:
    buffer_load_dwordx4 v[52:55], v1, s[44:47], s70 offen offset:256 nt
    s_add_u32 s76, s76, 1
    s_waitcnt lgkmcnt(0)
    v_readfirstlane_b32 s12, v234
    v_mov_b32 v29, s76
    ds_write_b32 v233, v29 offset:46400
    ds_read_b32 v234, v235 offset:46416
    s_cmp_lt_u32 s76, s12
    s_cselect_b64 vcc, -1, 0
    v_mfma_f32_16x16x32_bf16 v[12:15], v[76:79], v[16:19], v[12:15]
    v_and_b32_dpp v16, v2, v4 row_newbcast:9 row_mask:0xf bank_mask:0xf
    v_and_b32_dpp v17, v2, v5 row_newbcast:9 row_mask:0xf bank_mask:0xf
    v_and_b32_dpp v18, v2, v6 row_newbcast:9 row_mask:0xf bank_mask:0xf
    v_and_b32_dpp v19, v2, v7 row_newbcast:9 row_mask:0xf bank_mask:0xf
    s_nop 1
    v_mfma_f32_16x16x32_bf16 v[8:11], v[80:83], v[16:19], v[8:11]
    s_waitcnt vmcnt(5)
    s_cbranch_vccnz L_w_138
    s_waitcnt vmcnt(4)
L_w_138:
    buffer_load_dwordx4 v[56:59], v1, s[44:47], s70 offen offset:2048 nt
    v_mfma_f32_16x16x32_bf16 v[12:15], v[84:87], v[16:19], v[12:15]
    v_and_b32_dpp v16, v2, v4 row_newbcast:13 row_mask:0xf bank_mask:0xf
    v_and_b32_dpp v17, v2, v5 row_newbcast:13 row_mask:0xf bank_mask:0xf
    v_and_b32_dpp v18, v2, v6 row_newbcast:13 row_mask:0xf bank_mask:0xf
    v_and_b32_dpp v19, v2, v7 row_newbcast:13 row_mask:0xf bank_mask:0xf
    s_nop 1
    v_mfma_f32_16x16x32_bf16 v[8:11], v[88:91], v[16:19], v[8:11]
    s_waitcnt vmcnt(5)
    s_cbranch_vccnz L_w_139
    s_waitcnt vmcnt(4)
L_w_139:
    buffer_load_dwordx4 v[60:63], v1, s[44:47], s70 offen offset:2304 nt
    s_add_u32 s69, s69, 65536
    s_add_u32 s70, s70, 65536
    v_mfma_f32_16x16x32_bf16 v[12:15], v[92:95], v[16:19], v[12:15]
    v_and_b32_dpp v16, v2, v4 row_newbcast:2 row_mask:0xf bank_mask:0xf
    v_and_b32_dpp v17, v2, v5 row_newbcast:2 row_mask:0xf bank_mask:0xf
    v_and_b32_dpp v18, v2, v6 row_newbcast:2 row_mask:0xf bank_mask:0xf
    v_and_b32_dpp v19, v2, v7 row_newbcast:2 row_mask:0xf bank_mask:0xf
    s_nop 1
    v_mfma_f32_16x16x32_bf16 v[8:11], v[32:35], v[16:19], v[8:11]
    s_waitcnt vmcnt(5)
    s_cbranch_vccnz L_w_140
    s_waitcnt vmcnt(4)
L_w_140:
    buffer_load_dwordx4 v[64:67], v1, s[44:47], s69 offen offset:0 nt
    v_mfma_f32_16x16x32_bf16 v[12:15], v[36:39], v[16:19], v[12:15]
    v_and_b32_dpp v16, v2, v4 row_newbcast:6 row_mask:0xf bank_mask:0xf
    v_and_b32_dpp v17, v2, v5 row_newbcast:6 row_mask:0xf bank_mask:0xf
    v_and_b32_dpp v18, v2, v6 row_newbcast:6 row_mask:0xf bank_mask:0xf
    v_and_b32_dpp v19, v2, v7 row_newbcast:6 row_mask:0xf bank_mask:0xf
    s_nop 1
    v_mfma_f32_16x16x32_bf16 v[8:11], v[40:43], v[16:19], v[8:11]
    s_waitcnt vmcnt(5)
    s_cbranch_vccnz L_w_141
    s_waitcnt vmcnt(4)
L_w_141:
    buffer_load_dwordx4 v[68:71], v1, s[44:47], s69 offen offset:2048 nt
    s_add_u32 s76, s76, 1
    s_waitcnt lgkmcnt(0)
    v_readfirstlane_b32 s12, v234
    v_mov_b32 v29, s76
    ds_write_b32 v233, v29 offset:46400
    ds_read_b32 v234, v235 offset:46416
    s_cmp_lt_u32 s76, s12
    s_cselect_b64 vcc, -1, 0
    v_mfma_f32_16x16x32_bf16 v[12:15], v[44:47], v[16:19], v[12:15]
    v_and_b32_dpp v16, v2, v4 row_newbcast:10 row_mask:0xf bank_mask:0xf
    v_and_b32_dpp v17, v2, v5 row_newbcast:10 row_mask:0xf bank_mask:0xf
    v_and_b32_dpp v18, v2, v6 row_newbcast:10 row_mask:0xf bank_mask:0xf
    v_and_b32_dpp v19, v2, v7 row_newbcast:10 row_mask:0xf bank_mask:0xf
    s_nop 1
    s_waitcnt vmcnt(5)
    s_cbranch_vccnz L_w_142
    s_waitcnt vmcnt(4)
L_w_142:
    buffer_load_dwordx4 v[72:75], v1, s[44:47], s70 offen offset:0 nt
    v_mfma_f32_16x16x32_bf16 v[8:11], v[48:51], v[16:19], v[8:11]
    s_waitcnt vmcnt(5)
    s_cbranch_vccnz L_w_143
    s_waitcnt vmcnt(4)
L_w_143:
    buffer_load_dwordx4 v[76:79], v1, s[44:47], s70 offen offset:2048 nt
    v_mfma_f32_16x16x32_bf16 v[12:15], v[52:55], v[16:19], v[12:15]
    v_and_b32_dpp v16, v2, v4 row_newbcast:14 row_mask:0xf bank_mask:0xf
    v_and_b32_dpp v17, v2, v5 row_newbcast:14 row_mask:0xf bank_mask:0xf
    v_and_b32_dpp v18, v2, v6 row_newbcast:14 row_mask:0xf bank_mask:0xf
    v_and_b32_dpp v19, v2, v7 row_newbcast:14 row_mask:0xf bank_mask:0xf
    s_nop 1
    s_waitcnt vmcnt(5)
    s_cbranch_vccnz L_w_144
    s_waitcnt vmcnt(4)
L_w_144:
    buffer_load_dwordx4 v[80:83], v1, s[44:47], s69 offen offset:256 nt
    v_mfma_f32_16x16x32_bf16 v[8:11], v[56:59], v[16:19], v[8:11]
    s_waitcnt vmcnt(5)
    s_cbranch_vccnz L_w_145
    s_waitcnt vmcnt(4)
L_w_145:
    buffer_load_dwordx4 v[84:87], v1, s[44:47], s69 offen offset:2304 nt
    s_add_u32 s76, s76, 1
    s_waitcnt lgkmcnt(0)
    v_readfirstlane_b32 s12, v234
    v_mov_b32 v29, s76
    ds_write_b32 v233, v29 offset:46400
    ds_read_b32 v234, v235 offset:46416
    s_cmp_lt_u32 s76, s12
    s_cselect_b64 vcc, -1, 0
    v_mfma_f32_16x16x32_bf16 v[12:15], v[60:63], v[16:19], v[12:15]
    v_and_b32_dpp v16, v2, v4 row_newbcast:3 row_mask:0xf bank_mask:0xf
    v_and_b32_dpp v17, v2, v5 row_newbcast:3 row_mask:0xf bank_mask:0xf
    v_and_b32_dpp v18, v2, v6 row_newbcast:3 row_mask:0xf bank_mask:0xf
    v_and_b32_dpp v19, v2, v7 row_newbcast:3 row_mask:0xf bank_mask:0xf
    s_nop 1
    s_waitcnt vmcnt(5)
    s_cbranch_vccnz L_w_146
    s_waitcnt vmcnt(4)
L_w_146:
    buffer_load_dwordx4 v[88:91], v1, s[44:47], s70 offen offset:256 nt
    v_mfma_f32_16x16x32_bf16 v[8:11], v[64:67], v[16:19], v[8:11]
    v_and_b32_dpp v16, v2, v4 row_newbcast:7 row_mask:0xf bank_mask:0xf
    v_and_b32_dpp v17, v2, v5 row_newbcast:7 row_mask:0xf bank_mask:0xf
    v_and_b32_dpp v18, v2, v6 row_newbcast:7 row_mask:0xf bank_mask:0xf
    v_and_b32_dpp v19, v2, v7 row_newbcast:7 row_mask:0xf bank_mask:0xf
    s_nop 1
    s_waitcnt vmcnt(5)
    s_cbranch_vccnz L_w_147
    s_waitcnt vmcnt(4)
L_w_147:
    buffer_load_dwordx4 v[92:95], v1, s[44:47], s70 offen offset:2304 nt
    s_add_u32 s69, s69, 65536
    s_add_u32 s70, s70, 65536
    v_mfma_f32_16x16x32_bf16 v[8:11], v[68:71], v[16:19], v[8:11]
    v_and_b32_dpp v16, v2, v4 row_newbcast:11 row_mask:0xf bank_mask:0xf
    v_and_b32_dpp v17, v2, v5 row_newbcast:11 row_mask:0xf bank_mask:0xf
    v_and_b32_dpp v18, v2, v6 row_newbcast:11 row_mask:0xf bank_mask:0xf
    v_and_b32_dpp v19, v2, v7 row_newbcast:11 row_mask:0xf bank_mask:0xf
    s_nop 1
    s_mov_b32 s71, 7
L_vloop:
    s_waitcnt vmcnt(5)
    s_cbranch_vccnz L_w_148
    s_waitcnt vmcnt(4)
L_w_148:
    buffer_load_dwordx4 v[32:35], v1, s[44:47], s69 offen offset:0 nt
    v_mfma_f32_16x16x32_bf16 v[8:11], v[72:75], v[16:19], v[8:11]
    v_and_b32_dpp v16, v2, v4 row_newbcast:15 row_mask:0xf bank_mask:0xf
    v_and_b32_dpp v17, v2, v5 row_newbcast:15 row_mask:0xf bank_mask:0xf
    v_and_b32_dpp v18, v2, v6 row_newbcast:15 row_mask:0xf bank_mask:0xf
    v_and_b32_dpp v19, v2, v7 row_newbcast:15 row_mask:0xf bank_mask:0xf
    s_waitcnt vmcnt(5)
    s_cbranch_vccnz L_w_149
    s_waitcnt vmcnt(4)
L_w_149:
    buffer_load_dwordx4 v[36:39], v1, s[44:47], s69 offen offset:256 nt
    v_mfma_f32_16x16x32_bf16 v[8:11], v[76:79], v[16:19], v[8:11]
    v_and_b32_dpp v16, v2, v4 row_newbcast:3 row_mask:0xf bank_mask:0xf
    v_and_b32_dpp v17, v2, v5 row_newbcast:3 row_mask:0xf bank_mask:0xf
    v_and_b32_dpp v18, v2, v6 row_newbcast:3 row_mask:0xf bank_mask:0xf
    v_and_b32_dpp v19, v2, v7 row_newbcast:3 row_mask:0xf bank_mask:0xf
    s_add_u32 s76, s76, 1
    s_waitcnt lgkmcnt(0)
    v_readfirstlane_b32 s12, v234
    v_mov_b32 v29, s76
    ds_write_b32 v233, v29 offset:46400
    ds_read_b32 v234, v235 offset:46416
    s_cmp_lt_u32 s76, s12
    s_cselect_b64 vcc, -1, 0
    s_waitcnt vmcnt(5)
    s_cbranch_vccnz L_w_150
    s_waitcnt vmcnt(4)
L_w_150:
    buffer_load_dwordx4 v[40:43], v1, s[44:47], s69 offen offset:2048 nt
    v_mfma_f32_16x16x32_bf16 v[12:15], v[80:83], v[16:19], v[12:15]
    v_and_b32_dpp v16, v2, v4 row_newbcast:7 row_mask:0xf bank_mask:0xf
    v_and_b32_dpp v17, v2, v5 row_newbcast:7 row_mask:0xf bank_mask:0xf
    v_and_b32_dpp v18, v2, v6 row_newbcast:7 row_mask:0xf bank_mask:0xf
    v_and_b32_dpp v19, v2, v7 row_newbcast:7 row_mask:0xf bank_mask:0xf
    s_waitcnt vmcnt(5)
    s_cbranch_vccnz L_w_151
    s_waitcnt vmcnt(4)
L_w_151:
    buffer_load_dwordx4 v[44:47], v1, s[44:47], s69 offen offset:2304 nt
    v_mfma_f32_16x16x32_bf16 v[12:15], v[84:87], v[16:19], v[12:15]
    v_and_b32_dpp v16, v2, v4 row_newbcast:11 row_mask:0xf bank_mask:0xf
    v_and_b32_dpp v17, v2, v5 row_newbcast:11 row_mask:0xf bank_mask:0xf
    v_and_b32_dpp v18, v2, v6 row_newbcast:11 row_mask:0xf bank_mask:0xf
    v_and_b32_dpp v19, v2, v7 row_newbcast:11 row_mask:0xf bank_mask:0xf
    s_waitcnt vmcnt(5)
    s_cbranch_vccnz L_w_152
    s_waitcnt vmcnt(4)
L_w_152:
    buffer_load_dwordx4 v[48:51], v1, s[44:47], s70 offen offset:0 nt
    v_mfma_f32_16x16x32_bf16 v[12:15], v[88:91], v[16:19], v[12:15]
    v_and_b32_dpp v16, v2, v4 row_newbcast:15 row_mask:0xf bank_mask:0xf
    v_and_b32_dpp v17, v2, v5 row_newbcast:15 row_mask:0xf bank_mask:0xf
    v_and_b32_dpp v18, v2, v6 row_newbcast:15 row_mask:0xf bank_mask:0xf
    v_and_b32_dpp v19, v2, v7 row_newbcast:15 row_mask:0xf bank_mask:0xf
    s_waitcnt vmcnt(5)
    s_cbranch_vccnz L_w_153
    s_waitcnt vmcnt(4)
L_w_153:
    buffer_load_dwordx4 v[52:55], v1, s[44:47], s70 offen offset:256 nt
    v_mfma_f32_16x16x32_bf16 v[12:15], v[92:95], v[16:19], v[12:15]
    s_waitcnt lgkmcnt(0)
    v_mov_b32 v2, v3
    ds_read_b32 v3, v20 offset:4096
    v_add_u32 v20, 256, v20
    v_and_b32_dpp v16, v2, v4 row_newbcast:0 row_mask:0xf bank_mask:0xf
    v_and_b32_dpp v17, v2, v5 row_newbcast:0 row_mask:0xf bank_mask:0xf
    v_and_b32_dpp v18, v2, v6 row_newbcast:0 row_mask:0xf bank_mask:0xf
    v_and_b32_dpp v19, v2, v7 row_newbcast:0 row_mask:0xf bank_mask:0xf
    s_add_u32 s76, s76, 1
    s_waitcnt lgkmcnt(0)
    v_readfirstlane_b32 s12, v234
    v_mov_b32 v29, s76
    ds_write_b32 v233, v29 offset:46400
    ds_read_b32 v234, v235 offset:46416
    s_cmp_lt_u32 s76, s12
    s_cselect_b64 vcc, -1, 0
    s_waitcnt vmcnt(5)
    s_cbranch_vccnz L_w_154
    s_waitcnt vmcnt(4)
L_w_154:
    buffer_load_dwordx4 v[56:59], v1, s[44:47], s70 offen offset:2048 nt
    v_mfma_f32_16x16x32_bf16 v[8:11], v[32:35], v[16:19], v[8:11]
    s_waitcnt vmcnt(5)
    s_cbranch_vccnz L_w_155
    s_waitcnt vmcnt(4)
L_w_155:
    buffer_load_dwordx4 v[60:63], v1, s[44:47], s70 offen offset:2304 nt
    s_add_u32 s69, s69, 65536
    s_add_u32 s70, s70, 65536
    v_mfma_f32_16x16x32_bf16 v[12:15], v[36:39], v[16:19], v[12:15]
    v_and_b32_dpp v16, v2, v4 row_newbcast:4 row_mask:0xf bank_mask:0xf
    v_and_b32_dpp v17, v2, v5 row_newbcast:4 row_mask:0xf bank_mask:0xf
    v_and_b32_dpp v18, v2, v6 row_newbcast:4 row_mask:0xf bank_mask:0xf
    v_and_b32_dpp v19, v2, v7 row_newbcast:4 row_mask:0xf bank_mask:0xf
    s_waitcnt vmcnt(5)
    s_cbranch_vccnz L_w_156
    s_waitcnt vmcnt(4)
L_w_156:
    buffer_load_dwordx4 v[64:67], v1, s[44:47], s69 offen offset:0 nt
    v_mfma_f32_16x16x32_bf16 v[8:11], v[40:43], v[16:19], v[8:11]
    s_waitcnt vmcnt(5)
    s_cbranch_vccnz L_w_157
    s_waitcnt vmcnt(4)
L_w_157:
    buffer_load_dwordx4 v[68:71], v1, s[44:47], s69 offen offset:256 nt
    v_mfma_f32_16x16x32_bf16 v[12:15], v[44:47], v[16:19], v[12:15]
    v_and_b32_dpp v16, v2, v4 row_newbcast:8 row_mask:0xf bank_mask:0xf
    v_and_b32_dpp v17, v2, v5 row_newbcast:8 row_mask:0xf bank_mask:0xf
    v_and_b32_dpp v18, v2, v6 row_newbcast:8 row_mask:0xf bank_mask:0xf
    v_and_b32_dpp v19, v2, v7 row_newbcast:8 row_mask:0xf bank_mask:0xf
    s_add_u32 s76, s76, 1
    s_waitcnt lgkmcnt(0)
    v_readfirstlane_b32 s12, v234
    v_mov_b32 v29, s76
    ds_write_b32 v233, v29 offset:46400
    ds_read_b32 v234, v235 offset:46416
    s_cmp_lt_u32 s76, s12
    s_cselect_b64 vcc, -1, 0
    s_waitcnt vmcnt(5)
    s_cbranch_vccnz L_w_158
    s_waitcnt vmcnt(4)
L_w_158:
    buffer_load_dwordx4 v[72:75], v1, s[44:47], s69 offen offset:2048 nt
    v_mfma_f32_16x16x32_bf16 v[8:11], v[48:51], v[16:19], v[8:11]
    s_waitcnt vmcnt(5)
    s_cbranch_vccnz L_w_159
    s_waitcnt vmcnt(4)
L_w_159:
    buffer_load_dwordx4 v[76:79], v1, s[44:47], s69 offen offset:2304 nt
    v_mfma_f32_16x16x32_bf16 v[12:15], v[52:55], v[16:19], v[12:15]
    v_and_b32_dpp v16, v2, v4 row_newbcast:12 row_mask:0xf bank_mask:0xf
    v_and_b32_dpp v17, v2, v5 row_newbcast:12 row_mask:0xf bank_mask:0xf
    v_and_b32_dpp v18, v2, v6 row_newbcast:12 row_mask:0xf bank_mask:0xf
    v_and_b32_dpp v19, v2, v7 row_newbcast:12 row_mask:0xf bank_mask:0xf
    s_waitcnt vmcnt(5)
    s_cbranch_vccnz L_w_160
    s_waitcnt vmcnt(4)
L_w_160:
    buffer_load_dwordx4 v[80:83], v1, s[44:47], s70 offen offset:0 nt
    v_mfma_f32_16x16x32_bf16 v[8:11], v[56:59], v[16:19], v[8:11]
    s_waitcnt vmcnt(5)
    s_cbranch_vccnz L_w_161
    s_waitcnt vmcnt(4)
L_w_161:
    buffer_load_dwordx4 v[84:87], v1, s[44:47], s70 offen offset:256 nt
    v_mfma_f32_16x16x32_bf16 v[12:15], v[60:63], v[16:19], v[12:15]
    v_and_b32_dpp v16, v2, v4 row_newbcast:1 row_mask:0xf bank_mask:0xf
    v_and_b32_dpp v17, v2, v5 row_newbcast:1 row_mask:0xf bank_mask:0xf
    v_and_b32_dpp v18, v2, v6 row_newbcast:1 row_mask:0xf bank_mask:0xf
    v_and_b32_dpp v19, v2, v7 row_newbcast:1 row_mask:0xf bank_mask:0xf
    s_add_u32 s76, s76, 1
    s_waitcnt lgkmcnt(0)
    v_readfirstlane_b32 s12, v234
    v_mov_b32 v29, s76
    ds_write_b32 v233, v29 offset:46400
    ds_read_b32 v234, v235 offset:46416
    s_cmp_lt_u32 s76, s12
    s_cselect_b64 vcc, -1, 0
    s_waitcnt vmcnt(5)
    s_cbranch_vccnz L_w_162
    s_waitcnt vmcnt(4)
L_w_162:
    buffer_load_dwordx4 v[88:91], v1, s[44:47], s70 offen offset:2048 nt
    v_mfma_f32_16x16x32_bf16 v[8:11], v[64:67], v[16:19], v[8:11]
    s_waitcnt vmcnt(5)
    s_cbranch_vccnz L_w_163
    s_waitcnt vmcnt(4)
L_w_163:
    buffer_load_dwordx4 v[92:95], v1, s[44:47], s70 offen offset:2304 nt
    s_add_u32 s69, s69, 65536
    s_add_u32 s70, s70, 65536
    v_mfma_f32_16x16x32_bf16 v[12:15], v[68:71], v[16:19], v[12:15]
    v_and_b32_dpp v16, v2, v4 row_newbcast:5 row_mask:0xf bank_mask:0xf
    v_and_b32_dpp v17, v2, v5 row_newbcast:5 row_mask:0xf bank_mask:0xf
    v_and_b32_dpp v18, v2, v6 row_newbcast:5 row_mask:0xf bank_mask:0xf
    v_and_b32_dpp v19, v2, v7 row_newbcast:5 row_mask:0xf bank_mask:0xf
    s_waitcnt vmcnt(5)
    s_cbranch_vccnz L_w_164
    s_waitcnt vmcnt(4)
L_w_164:
    buffer_load_dwordx4 v[32:35], v1, s[44:47], s69 offen offset:0 nt
    v_mfma_f32_16x16x32_bf16 v[8:11], v[72:75], v[16:19], v[8:11]
    s_waitcnt vmcnt(5)
    s_cbranch_vccnz L_w_165
    s_waitcnt vmcnt(4)
L_w_165:
    buffer_load_dwordx4 v[36:39], v1, s[44:47], s69 offen offset:256 nt
    v_mfma_f32_16x16x32_bf16 v[12:15], v[76:79], v[16:19], v[12:15]
    v_and_b32_dpp v16, v2, v4 row_newbcast:9 row_mask:0xf bank_mask:0xf
    v_and_b32_dpp v17, v2, v5 row_newbcast:9 row_mask:0xf bank_mask:0xf
    v_and_b32_dpp v18, v2, v6 row_newbcast:9 row_mask:0xf bank_mask:0xf
    v_and_b32_dpp v19, v2, v7 row_newbcast:9 row_mask:0xf bank_mask:0xf
    s_add_u32 s76, s76, 1
    s_waitcnt lgkmcnt(0)
    v_readfirstlane_b32 s12, v234
    v_mov_b32 v29, s76
    ds_write_b32 v233, v29 offset:46400
    ds_read_b32 v234, v235 offset:46416
    s_cmp_lt_u32 s76, s12
    s_cselect_b64 vcc, -1, 0
    s_waitcnt vmcnt(5)
    s_cbranch_vccnz L_w_166
    s_waitcnt vmcnt(4)
L_w_166:
    buffer_load_dwordx4 v[40:43], v1, s[44:47], s69 offen offset:2048 nt
    v_mfma_f32_16x16x32_bf16 v[8:11], v[80:83], v[16:19], v[8:11]
    s_waitcnt vmcnt(5)
    s_cbranch_vccnz L_w_167
    s_waitcnt vmcnt(4)
L_w_167:
    buffer_load_dwordx4 v[44:47], v1, s[44:47], s69 offen offset:2304 nt
    v_mfma_f32_16x16x32_bf16 v[12:15], v[84:87], v[16:19], v[12:15]
    v_and_b32_dpp v16, v2, v4 row_newbcast:13 row_mask:0xf bank_mask:0xf
    v_and_b32_dpp v17, v2, v5 row_newbcast:13 row_mask:0xf bank_mask:0xf
    v_and_b32_dpp v18, v2, v6 row_newbcast:13 row_mask:0xf bank_mask:0xf
    v_and_b32_dpp v19, v2, v7 row_newbcast:13 row_mask:0xf bank_mask:0xf
    s_waitcnt vmcnt(5)
    s_cbranch_vccnz L_w_168
    s_waitcnt vmcnt(4)
L_w_168:
    buffer_load_dwordx4 v[48:51], v1, s[44:47], s70 offen offset:0 nt
    v_mfma_f32_16x16x32_bf16 v[8:11], v[88:91], v[16:19], v[8:11]
    s_waitcnt vmcnt(5)
    s_cbranch_vccnz L_w_169
    s_waitcnt vmcnt(4)
L_w_169:
    buffer_load_dwordx4 v[52:55], v1, s[44:47], s70 offen offset:256 nt
    v_mfma_f32_16x16x32_bf16 v[12:15], v[92:95], v[16:19], v[12:15]
    v_and_b32_dpp v16, v2, v4 row_newbcast:2 row_mask:0xf bank_mask:0xf
    v_and_b32_dpp v17, v2, v5 row_newbcast:2 row_mask:0xf bank_mask:0xf
    v_and_b32_dpp v18, v2, v6 row_newbcast:2 row_mask:0xf bank_mask:0xf
    v_and_b32_dpp v19, v2, v7 row_newbcast:2 row_mask:0xf bank_mask:0xf
    s_add_u32 s76, s76, 1
    s_waitcnt lgkmcnt(0)
    v_readfirstlane_b32 s12, v234
    v_mov_b32 v29, s76
    ds_write_b32 v233, v29 offset:46400
    ds_read_b32 v234, v235 offset:46416
    s_cmp_lt_u32 s76, s12
    s_cselect_b64 vcc, -1, 0
    s_waitcnt vmcnt(5)
    s_cbranch_vccnz L_w_170
    s_waitcnt vmcnt(4)
L_w_170:
    buffer_load_dwordx4 v[56:59], v1, s[44:47], s70 offen offset:2048 nt
    v_mfma_f32_16x16x32_bf16 v[8:11], v[32:35], v[16:19], v[8:11]
    s_waitcnt vmcnt(5)
    s_cbranch_vccnz L_w_171
    s_waitcnt vmcnt(4)
L_w_171:
    buffer_load_dwordx4 v[60:63], v1, s[44:47], s70 offen offset:2304 nt
    s_add_u32 s69, s69, 65536
    s_add_u32 s70, s70, 65536
    v_mfma_f32_16x16x32_bf16 v[12:15], v[36:39], v[16:19], v[12:15]
    v_and_b32_dpp v16, v2, v4 row_newbcast:6 row_mask:0xf bank_mask:0xf
    v_and_b32_dpp v17, v2, v5 row_newbcast:6 row_mask:0xf bank_mask:0xf
    v_and_b32_dpp v18, v2, v6 row_newbcast:6 row_mask:0xf bank_mask:0xf
    v_and_b32_dpp v19, v2, v7 row_newbcast:6 row_mask:0xf bank_mask:0xf
    s_waitcnt vmcnt(5)
    s_cbranch_vccnz L_w_172
    s_waitcnt vmcnt(4)
L_w_172:
    buffer_load_dwordx4 v[64:67], v1, s[44:47], s69 offen offset:0 nt
    v_mfma_f32_16x16x32_bf16 v[8:11], v[40:43], v[16:19], v[8:11]
    s_waitcnt vmcnt(5)
    s_cbranch_vccnz L_w_173
    s_waitcnt vmcnt(4)
L_w_173:
    buffer_load_dwordx4 v[68:71], v1, s[44:47], s69 offen offset:2048 nt
    v_mfma_f32_16x16x32_bf16 v[12:15], v[44:47], v[16:19], v[12:15]
    v_and_b32_dpp v16, v2, v4 row_newbcast:10 row_mask:0xf bank_mask:0xf
    v_and_b32_dpp v17, v2, v5 row_newbcast:10 row_mask:0xf bank_mask:0xf
    v_and_b32_dpp v18, v2, v6 row_newbcast:10 row_mask:0xf bank_mask:0xf
    v_and_b32_dpp v19, v2, v7 row_newbcast:10 row_mask:0xf bank_mask:0xf
    s_add_u32 s76, s76, 1
    s_waitcnt lgkmcnt(0)
    v_readfirstlane_b32 s12, v234
    v_mov_b32 v29, s76
    ds_write_b32 v233, v29 offset:46400
    ds_read_b32 v234, v235 offset:46416
    s_cmp_lt_u32 s76, s12
    s_cselect_b64 vcc, -1, 0
    s_waitcnt vmcnt(5)
    s_cbranch_vccnz L_w_174
    s_waitcnt vmcnt(4)
L_w_174:
    buffer_load_dwordx4 v[72:75], v1, s[44:47], s70 offen offset:0 nt
    v_mfma_f32_16x16x32_bf16 v[8:11], v[48:51], v[16:19], v[8:11]
    s_waitcnt vmcnt(5)
    s_cbranch_vccnz L_w_175
    s_waitcnt vmcnt(4)
L_w_175:
    buffer_load_dwordx4 v[76:79], v1, s[44:47], s70 offen offset:2048 nt
    v_mfma_f32_16x16x32_bf16 v[12:15], v[52:55], v[16:19], v[12:15]
    v_and_b32_dpp v16, v2, v4 row_newbcast:14 row_mask:0xf bank_mask:0xf
    v_and_b32_dpp v17, v2, v5 row_newbcast:14 row_mask:0xf bank_mask:0xf
    v_and_b32_dpp v18, v2, v6 row_newbcast:14 row_mask:0xf bank_mask:0xf
    v_and_b32_dpp v19, v2, v7 row_newbcast:14 row_mask:0xf bank_mask:0xf
    s_waitcnt vmcnt(5)
    s_cbranch_vccnz L_w_176
    s_waitcnt vmcnt(4)
L_w_176:
    buffer_load_dwordx4 v[80:83], v1, s[44:47], s69 offen offset:256 nt
    v_mfma_f32_16x16x32_bf16 v[8:11], v[56:59], v[16:19], v[8:11]
    s_waitcnt vmcnt(5)
    s_cbranch_vccnz L_w_177
    s_waitcnt vmcnt(4)
L_w_177:
    buffer_load_dwordx4 v[84:87], v1, s[44:47], s69 offen offset:2304 nt
    v_mfma_f32_16x16x32_bf16 v[12:15], v[60:63], v[16:19], v[12:15]
    v_and_b32_dpp v16, v2, v4 row_newbcast:3 row_mask:0xf bank_mask:0xf
    v_and_b32_dpp v17, v2, v5 row_newbcast:3 row_mask:0xf bank_mask:0xf
    v_and_b32_dpp v18, v2, v6 row_newbcast:3 row_mask:0xf bank_mask:0xf
    v_and_b32_dpp v19, v2, v7 row_newbcast:3 row_mask:0xf bank_mask:0xf
    s_add_u32 s76, s76, 1
    s_waitcnt lgkmcnt(0)
    v_readfirstlane_b32 s12, v234
    v_mov_b32 v29, s76
    ds_write_b32 v233, v29 offset:46400
    ds_read_b32 v234, v235 offset:46416
    s_cmp_lt_u32 s76, s12
    s_cselect_b64 vcc, -1, 0
    s_waitcnt vmcnt(5)
    s_cbranch_vccnz L_w_178
    s_waitcnt vmcnt(4)
L_w_178:
    buffer_load_dwordx4 v[88:91], v1, s[44:47], s70 offen offset:256 nt
    v_mfma_f32_16x16x32_bf16 v[8:11], v[64:67], v[16:19], v[8:11]
    v_and_b32_dpp v16, v2, v4 row_newbcast:7 row_mask:0xf bank_mask:0xf
    v_and_b32_dpp v17, v2, v5 row_newbcast:7 row_mask:0xf bank_mask:0xf
    v_and_b32_dpp v18, v2, v6 row_newbcast:7 row_mask:0xf bank_mask:0xf
    v_and_b32_dpp v19, v2, v7 row_newbcast:7 row_mask:0xf bank_mask:0xf
    s_waitcnt vmcnt(5)
    s_cbranch_vccnz L_w_179
    s_waitcnt vmcnt(4)
L_w_179:
    buffer_load_dwordx4 v[92:95], v1, s[44:47], s70 offen offset:2304 nt
    s_add_u32 s69, s69, 65536
    s_add_u32 s70, s70, 65536
    v_mfma_f32_16x16x32_bf16 v[8:11], v[68:71], v[16:19], v[8:11]
    v_and_b32_dpp v16, v2, v4 row_newbcast:11 row_mask:0xf bank_mask:0xf
    v_and_b32_dpp v17, v2, v5 row_newbcast:11 row_mask:0xf bank_mask:0xf
    v_and_b32_dpp v18, v2, v6 row_newbcast:11 row_mask:0xf bank_mask:0xf
    v_and_b32_dpp v19, v2, v7 row_newbcast:11 row_mask:0xf bank_mask:0xf
    s_sub_u32 s71, s71, 1
    s_cmp_lg_u32 s71, 0
    s_cbranch_scc1 L_vloop
    s_nop 0
    s_waitcnt vmcnt(5)
    v_mfma_f32_16x16x32_bf16 v[8:11], v[72:75], v[16:19], v[8:11]
    v_and_b32_dpp v16, v2, v4 row_newbcast:15 row_mask:0xf bank_mask:0xf
    v_and_b32_dpp v17, v2, v5 row_newbcast:15 row_mask:0xf bank_mask:0xf
    v_and_b32_dpp v18, v2, v6 row_newbcast:15 row_mask:0xf bank_mask:0xf
    v_and_b32_dpp v19, v2, v7 row_newbcast:15 row_mask:0xf bank_mask:0xf
    s_nop 1
    s_waitcnt vmcnt(4)
    v_mfma_f32_16x16x32_bf16 v[8:11], v[76:79], v[16:19], v[8:11]
    v_and_b32_dpp v16, v2, v4 row_newbcast:3 row_mask:0xf bank_mask:0xf
    v_and_b32_dpp v17, v2, v5 row_newbcast:3 row_mask:0xf bank_mask:0xf
    v_and_b32_dpp v18, v2, v6 row_newbcast:3 row_mask:0xf bank_mask:0xf
    v_and_b32_dpp v19, v2, v7 row_newbcast:3 row_mask:0xf bank_mask:0xf
    s_nop 1
    s_waitcnt vmcnt(3)
    v_mfma_f32_16x16x32_bf16 v[12:15], v[80:83], v[16:19], v[12:15]
    v_and_b32_dpp v16, v2, v4 row_newbcast:7 row_mask:0xf bank_mask:0xf
    v_and_b32_dpp v17, v2, v5 row_newbcast:7 row_mask:0xf bank_mask:0xf
    v_and_b32_dpp v18, v2, v6 row_newbcast:7 row_mask:0xf bank_mask:0xf
    v_and_b32_dpp v19, v2, v7 row_newbcast:7 row_mask:0xf bank_mask:0xf
    s_nop 1
    s_mov_b32 exec_lo, 0x00ff00ff
    s_mov_b32 exec_hi, 0x00ff00ff
    ds_write_b128 v21, v[8:11] offset:12352
    s_mov_b64 exec, -1
    s_waitcnt lgkmcnt(0)
    s_barrier
    s_waitcnt vmcnt(2)
    v_mfma_f32_16x16x32_bf16 v[12:15], v[84:87], v[16:19], v[12:15]
    v_and_b32_dpp v16, v2, v4 row_newbcast:11 row_mask:0xf bank_mask:0xf
    v_and_b32_dpp v17, v2, v5 row_newbcast:11 row_mask:0xf bank_mask:0xf
    v_and_b32_dpp v18, v2, v6 row_newbcast:11 row_mask:0xf bank_mask:0xf
    v_and_b32_dpp v19, v2, v7 row_newbcast:11 row_mask:0xf bank_mask:0xf
    s_nop 1
    s_waitcnt vmcnt(1)
    v_mfma_f32_16x16x32_bf16 v[12:15], v[88:91], v[16:19], v[12:15]
    v_and_b32_dpp v16, v2, v4 row_newbcast:15 row_mask:0xf bank_mask:0xf
    v_and_b32_dpp v17, v2, v5 row_newbcast:15 row_mask:0xf bank_mask:0xf
    v_and_b32_dpp v18, v2, v6 row_newbcast:15 row_mask:0xf bank_mask:0xf
    v_and_b32_dpp v19, v2, v7 row_newbcast:15 row_mask:0xf bank_mask:0xf
    s_nop 1
    s_waitcnt vmcnt(0)
    v_mfma_f32_16x16x32_bf16 v[12:15], v[92:95], v[16:19], v[12:15]
    s_mov_b32 exec_lo, 0x00ff00ff
    s_mov_b32 exec_hi, 0x00ff00ff
    s_lshl_b32 s69, s9, 14
    s_mov_b32 s72, 0xff
    s_nop 2
    s_nop 0
    s_nop 0
    ds_write_b128 v21, v[12:15] offset:12416
    s_mov_b64 exec, -1
    s_waitcnt lgkmcnt(0)
    s_setprio 1
    s_barrier
    s_cmp_ge_u32 s8, 28
    s_cbranch_scc1 L_nomlp_181
    v_mov_b32 v8, 0
    v_mov_b32 v9, 0
    v_mov_b32 v10, 0
    v_mov_b32 v11, 0
    v_mov_b32 v12, 0
    v_mov_b32 v13, 0
    v_mov_b32 v14, 0
    v_mov_b32 v15, 0
    v_add_u32 v28, 4294925504, v230
    ds_read2st64_b32 v[240:241], v28 offset0:0 offset1:1
    ds_read2st64_b32 v[242:243], v28 offset0:2 offset1:3
    ds_read2st64_b32 v[244:245], v28 offset0:4 offset1:5
    ds_read2st64_b32 v[246:247], v28 offset0:6 offset1:7
    s_mov_b32 s71, 1048576
    s_mov_b32 s74, 1
    s_mov_b32 s73, s72
    s_branch L_gissue
L_ground:
    s_bcnt1_i32_b32 s12, s72
    s_mov_b32 s73, s72
    s_cmp_eq_u32 s12, 1
    s_cbranch_scc1 L_gsingle
L_gissue:
    s_bitcmp1_b32 s73, 0
    s_cbranch_scc0 L_gi_182
    s_add_u32 s12, s69, 0
    buffer_load_dwordx4 v[36:39], v22, s[56:59], s12 offen sc1
L_gi_182:
    s_bitcmp1_b32 s73, 1
    s_cbranch_scc0 L_gi_183
    s_add_u32 s12, s69, 2048
    buffer_load_dwordx4 v[44:47], v22, s[56:59], s12 offen sc1
L_gi_183:
    s_bitcmp1_b32 s73, 2
    s_cbranch_scc0 L_gi_184
    s_add_u32 s12, s69, 4096
    buffer_load_dwordx4 v[52:55], v22, s[56:59], s12 offen sc1
L_gi_184:
    s_bitcmp1_b32 s73, 3
    s_cbranch_scc0 L_gi_185
    s_add_u32 s12, s69, 6144
    buffer_load_dwordx4 v[60:63], v22, s[56:59], s12 offen sc1
L_gi_185:
    s_bitcmp1_b32 s73, 4
    s_cbranch_scc0 L_gi_186
    s_add_u32 s12, s69, 8192
    buffer_load_dwordx4 v[68:71], v22, s[56:59], s12 offen sc1
L_gi_186:
    s_bitcmp1_b32 s73, 5
    s_cbranch_scc0 L_gi_187
    s_add_u32 s12, s69, 10240
    buffer_load_dwordx4 v[76:79], v22, s[56:59], s12 offen sc1
L_gi_187:
    s_bitcmp1_b32 s73, 6
    s_cbranch_scc0 L_gi_188
    s_add_u32 s12, s69, 12288
    buffer_load_dwordx4 v[84:87], v22, s[56:59], s12 offen sc1
L_gi_188:
    s_bitcmp1_b32 s73, 7
    s_cbranch_scc0 L_gi_189
    s_add_u32 s12, s69, 14336
    buffer_load_dwordx4 v[92:95], v22, s[56:59], s12 offen sc1
L_gi_189:
    s_cmp_eq_u32 s74, 0
    s_cbranch_scc1 L_gnob
    s_barrier
    s_mov_b32 s74, 0
    s_waitcnt lgkmcnt(0)
    v_pk_add_f32 v[240:241], v[240:241], v[242:243]
    v_pk_add_f32 v[244:245], v[244:245], v[246:247]
    v_pk_add_f32 v[240:241], v[240:241], v[244:245]
    v_add_f32 v236, v240, v241
L_gnob:
    s_waitcnt vmcnt(0) lgkmcnt(0)
    s_bitcmp1_b32 s73, 0
    s_cbranch_scc0 L_gc_190
    v_xor_b32 v39, s43, v39
    v_cmp_lt_u32 vcc, 0xffff, v39
    s_cbranch_vccnz L_gc_190
    v_lshlrev_b32 v32, 16, v36
    v_and_b32 v33, 0xffff0000, v36
    v_lshlrev_b32 v34, 16, v37
    v_and_b32 v35, 0xffff0000, v37
    v_lshlrev_b32 v36, 16, v38
    v_and_b32 v37, 0xffff0000, v38
    v_lshlrev_b32 v38, 16, v39
    s_bitset0_b32 s72, 0
L_gc_190:
    s_bitcmp1_b32 s73, 1
    s_cbranch_scc0 L_gc_191
    v_xor_b32 v47, s43, v47
    v_cmp_lt_u32 vcc, 0xffff, v47
    s_cbranch_vccnz L_gc_191
    v_lshlrev_b32 v40, 16, v44
    v_and_b32 v41, 0xffff0000, v44
    v_lshlrev_b32 v42, 16, v45
    v_and_b32 v43, 0xffff0000, v45
    v_lshlrev_b32 v44, 16, v46
    v_and_b32 v45, 0xffff0000, v46
    v_lshlrev_b32 v46, 16, v47
    s_bitset0_b32 s72, 1
L_gc_191:
    s_bitcmp1_b32 s73, 2
    s_cbranch_scc0 L_gc_192
    v_xor_b32 v55, s43, v55
    v_cmp_lt_u32 vcc, 0xffff, v55
    s_cbranch_vccnz L_gc_192
    v_lshlrev_b32 v48, 16, v52
    v_and_b32 v49, 0xffff0000, v52
    v_lshlrev_b32 v50, 16, v53
    v_and_b32 v51, 0xffff0000, v53
    v_lshlrev_b32 v52, 16, v54
    v_and_b32 v53, 0xffff0000, v54
    v_lshlrev_b32 v54, 16, v55
    s_bitset0_b32 s72, 2
L_gc_192:
    s_bitcmp1_b32 s73, 3
    s_cbranch_scc0 L_gc_193
    v_xor_b32 v63, s43, v63
    v_cmp_lt_u32 vcc, 0xffff, v63
    s_cbranch_vccnz L_gc_193
    v_lshlrev_b32 v56, 16, v60
    v_and_b32 v57, 0xffff0000, v60
    v_lshlrev_b32 v58, 16, v61
    v_and_b32 v59, 0xffff0000, v61
    v_lshlrev_b32 v60, 16, v62
    v_and_b32 v61, 0xffff0000, v62
    v_lshlrev_b32 v62, 16, v63
    s_bitset0_b32 s72, 3
L_gc_193:
    s_bitcmp1_b32 s73, 4
    s_cbranch_scc0 L_gc_194
    v_xor_b32 v71, s43, v71
    v_cmp_lt_u32 vcc, 0xffff, v71
    s_cbranch_vccnz L_gc_194
    v_lshlrev_b32 v64, 16, v68
    v_and_b32 v65, 0xffff0000, v68
    v_lshlrev_b32 v66, 16, v69
    v_and_b32 v67, 0xffff0000, v69
    v_lshlrev_b32 v68, 16, v70
    v_and_b32 v69, 0xffff0000, v70
    v_lshlrev_b32 v70, 16, v71
    s_bitset0_b32 s72, 4
L_gc_194:
    s_bitcmp1_b32 s73, 5
    s_cbranch_scc0 L_gc_195
    v_xor_b32 v79, s43, v79
    v_cmp_lt_u32 vcc, 0xffff, v79
    s_cbranch_vccnz L_gc_195
    v_lshlrev_b32 v72, 16, v76
    v_and_b32 v73, 0xffff0000, v76
    v_lshlrev_b32 v74, 16, v77
    v_and_b32 v75, 0xffff0000, v77
    v_lshlrev_b32 v76, 16, v78
    v_and_b32 v77, 0xffff0000, v78
    v_lshlrev_b32 v78, 16, v79
    s_bitset0_b32 s72, 5
L_gc_195:
    s_bitcmp1_b32 s73, 6
    s_cbranch_scc0 L_gc_196
    v_xor_b32 v87, s43, v87
    v_cmp_lt_u32 vcc, 0xffff, v87
    s_cbranch_vccnz L_gc_196
    v_lshlrev_b32 v80, 16, v84
    v_and_b32 v81, 0xffff0000, v84
    v_lshlrev_b32 v82, 16, v85
    v_and_b32 v83, 0xffff0000, v85
    v_lshlrev_b32 v84, 16, v86
    v_and_b32 v85, 0xffff0000, v86
    v_lshlrev_b32 v86, 16, v87
    s_bitset0_b32 s72, 6
L_gc_196:
    s_bitcmp1_b32 s73, 7
    s_cbranch_scc0 L_gc_197
    v_xor_b32 v95, s43, v95
    v_cmp_lt_u32 vcc, 0xffff, v95
    s_cbranch_vccnz L_gc_197
    v_lshlrev_b32 v88, 16, v92
    v_and_b32 v89, 0xffff0000, v92
    v_lshlrev_b32 v90, 16, v93
    v_and_b32 v91, 0xffff0000, v93
    v_lshlrev_b32 v92, 16, v94
    v_and_b32 v93, 0xffff0000, v94
    v_lshlrev_b32 v94, 16, v95
    s_bitset0_b32 s72, 7
L_gc_197:
    s_cmp_eq_u32 s72, 0
    s_cbranch_scc1 L_gdone
    s_sleep 2
    s_sub_u32 s71, s71, 1
    s_cmp_lg_u32 s71, 0
    s_cbranch_scc1 L_ground
    s_branch L_gdone
L_gsingle:
    s_ff1_i32_b32 s12, s72
    s_lshl_b32 s12, s12, 11
    s_add_u32 s12, s12, s69
    buffer_load_dwordx4 v[16:19], v22, s[56:59], s12 offen sc1
    s_bitcmp1_b32 s72, 0
    s_cbranch_scc1 L_gh0
    s_bitcmp1_b32 s72, 1
    s_cbranch_scc1 L_gh1
    s_bitcmp1_b32 s72, 2
    s_cbranch_scc1 L_gh2
    s_bitcmp1_b32 s72, 3
    s_cbranch_scc1 L_gh3
    s_bitcmp1_b32 s72, 4
    s_cbranch_scc1 L_gh4
    s_bitcmp1_b32 s72, 5
    s_cbranch_scc1 L_gh5
    s_bitcmp1_b32 s72, 6
    s_cbranch_scc1 L_gh6
L_gh7:
    v_pk_add_f32 v[32:33], v[32:33], v[40:41]
    v_pk_add_f32 v[34:35], v[34:35], v[42:43]
    v_pk_add_f32 v[36:37], v[36:37], v[44:45]
    v_pk_add_f32 v[38:39], v[38:39], v[46:47]
    v_pk_add_f32 v[48:49], v[48:49], v[56:57]
    v_pk_add_f32 v[50:51], v[50:51], v[58:59]
    v_pk_add_f32 v[52:53], v[52:53], v[60:61]
    v_pk_add_f32 v[54:55], v[54:55], v[62:63]
    v_pk_add_f32 v[240:241], v[32:33], v[48:49]
    v_pk_add_f32 v[242:243], v[34:35], v[50:51]
    v_pk_add_f32 v[244:245], v[36:37], v[52:53]
    v_pk_add_f32 v[246:247], v[38:39], v[54:55]
    v_pk_add_f32 v[248:249], v[64:65], v[72:73]
    v_pk_add_f32 v[250:251], v[66:67], v[74:75]
    v_pk_add_f32 v[252:253], v[68:69], v[76:77]
    v_pk_add_f32 v[254:255], v[70:71], v[78:79]
    v_pk_mov_b32 v[32:33], v[80:81], v[80:81] op_sel:[0,1]
    v_pk_mov_b32 v[34:35], v[82:83], v[82:83] op_sel:[0,1]
    v_pk_mov_b32 v[36:37], v[84:85], v[84:85] op_sel:[0,1]
    v_pk_mov_b32 v[38:39], v[86:87], v[86:87] op_sel:[0,1]
    s_branch L_gpoll
L_gh6:
    v_pk_add_f32 v[32:33], v[32:33], v[40:41]
    v_pk_add_f32 v[34:35], v[34:35], v[42:43]
    v_pk_add_f32 v[36:37], v[36:37], v[44:45]
    v_pk_add_f32 v[38:39], v[38:39], v[46:47]
    v_pk_add_f32 v[48:49], v[48:49], v[56:57]
    v_pk_add_f32 v[50:51], v[50:51], v[58:59]
    v_pk_add_f32 v[52:53], v[52:53], v[60:61]
    v_pk_add_f32 v[54:55], v[54:55], v[62:63]
    v_pk_add_f32 v[240:241], v[32:33], v[48:49]
    v_pk_add_f32 v[242:243], v[34:35], v[50:51]
    v_pk_add_f32 v[244:245], v[36:37], v[52:53]
    v_pk_add_f32 v[246:247], v[38:39], v[54:55]
    v_pk_add_f32 v[248:249], v[64:65], v[72:73]
    v_pk_add_f32 v[250:251], v[66:67], v[74:75]
    v_pk_add_f32 v[252:253], v[68:69], v[76:77]
    v_pk_add_f32 v[254:255], v[70:71], v[78:79]
    v_pk_mov_b32 v[32:33], v[88:89], v[88:89] op_sel:[0,1]
    v_pk_mov_b32 v[34:35], v[90:91], v[90:91] op_sel:[0,1]
    v_pk_mov_b32 v[36:37], v[92:93], v[92:93] op_sel:[0,1]
    v_pk_mov_b32 v[38:39], v[94:95], v[94:95] op_sel:[0,1]
    s_branch L_gpoll
L_gh5:
    v_pk_add_f32 v[32:33], v[32:33], v[40:41]
    v_pk_add_f32 v[34:35], v[34:35], v[42:43]
    v_pk_add_f32 v[36:37], v[36:37], v[44:45]
    v_pk_add_f32 v[38:39], v[38:39], v[46:47]
    v_pk_add_f32 v[48:49], v[48:49], v[56:57]
    v_pk_add_f32 v[50:51], v[50:51], v[58:59]
    v_pk_add_f32 v[52:53], v[52:53], v[60:61]
    v_pk_add_f32 v[54:55], v[54:55], v[62:63]
    v_pk_add_f32 v[240:241], v[32:33], v[48:49]
    v_pk_add_f32 v[242:243], v[34:35], v[50:51]
    v_pk_add_f32 v[244:245], v[36:37], v[52:53]
    v_pk_add_f32 v[246:247], v[38:39], v[54:55]
    v_pk_add_f32 v[248:249], v[80:81], v[88:89]
    v_pk_add_f32 v[250:251], v[82:83], v[90:91]
    v_pk_add_f32 v[252:253], v[84:85], v[92:93]
    v_pk_add_f32 v[254:255], v[86:87], v[94:95]
    v_pk_mov_b32 v[32:33], v[64:65], v[64:65] op_sel:[0,1]
    v_pk_mov_b32 v[34:35], v[66:67], v[66:67] op_sel:[0,1]
    v_pk_mov_b32 v[36:37], v[68:69], v[68:69] op_sel:[0,1]
    v_pk_mov_b32 v[38:39], v[70:71], v[70:71] op_sel:[0,1]
    s_branch L_gpoll
L_gh4:
    v_pk_add_f32 v[32:33], v[32:33], v[40:41]
    v_pk_add_f32 v[34:35], v[34:35], v[42:43]
    v_pk_add_f32 v[36:37], v[36:37], v[44:45]
    v_pk_add_f32 v[38:39], v[38:39], v[46:47]
    v_pk_add_f32 v[48:49], v[48:49], v[56:57]
    v_pk_add_f32 v[50:51], v[50:51], v[58:59]
    v_pk_add_f32 v[52:53], v[52:53], v[60:61]
    v_pk_add_f32 v[54:55], v[54:55], v[62:63]
    v_pk_add_f32 v[240:241], v[32:33], v[48:49]
    v_pk_add_f32 v[242:243], v[34:35], v[50:51]
    v_pk_add_f32 v[244:245], v[36:37], v[52:53]
    v_pk_add_f32 v[246:247], v[38:39], v[54:55]
    v_pk_add_f32 v[248:249], v[80:81], v[88:89]
    v_pk_add_f32 v[250:251], v[82:83], v[90:91]
    v_pk_add_f32 v[252:253], v[84:85], v[92:93]
    v_pk_add_f32 v[254:255], v[86:87], v[94:95]
    v_pk_mov_b32 v[32:33], v[72:73], v[72:73] op_sel:[0,1]
    v_pk_mov_b32 v[34:35], v[74:75], v[74:75] op_sel:[0,1]
    v_pk_mov_b32 v[36:37], v[76:77], v[76:77] op_sel:[0,1]
    v_pk_mov_b32 v[38:39], v[78:79], v[78:79] op_sel:[0,1]
    s_branch L_gpoll
L_gh3:
    v_pk_add_f32 v[64:65], v[64:65], v[72:73]
    v_pk_add_f32 v[66:67], v[66:67], v[74:75]
    v_pk_add_f32 v[68:69], v[68:69], v[76:77]
    v_pk_add_f32 v[70:71], v[70:71], v[78:79]
    v_pk_add_f32 v[80:81], v[80:81], v[88:89]
    v_pk_add_f32 v[82:83], v[82:83], v[90:91]
    v_pk_add_f32 v[84:85], v[84:85], v[92:93]
    v_pk_add_f32 v[86:87], v[86:87], v[94:95]
    v_pk_add_f32 v[240:241], v[64:65], v[80:81]
    v_pk_add_f32 v[242:243], v[66:67], v[82:83]
    v_pk_add_f32 v[244:245], v[68:69], v[84:85]
    v_pk_add_f32 v[246:247], v[70:71], v[86:87]
    v_pk_add_f32 v[248:249], v[32:33], v[40:41]
    v_pk_add_f32 v[250:251], v[34:35], v[42:43]
    v_pk_add_f32 v[252:253], v[36:37], v[44:45]
    v_pk_add_f32 v[254:255], v[38:39], v[46:47]
    v_pk_mov_b32 v[32:33], v[48:49], v[48:49] op_sel:[0,1]
    v_pk_mov_b32 v[34:35], v[50:51], v[50:51] op_sel:[0,1]
    v_pk_mov_b32 v[36:37], v[52:53], v[52:53] op_sel:[0,1]
    v_pk_mov_b32 v[38:39], v[54:55], v[54:55] op_sel:[0,1]
    s_branch L_gpoll
L_gh2:
    v_pk_add_f32 v[64:65], v[64:65], v[72:73]
    v_pk_add_f32 v[66:67], v[66:67], v[74:75]
    v_pk_add_f32 v[68:69], v[68:69], v[76:77]
    v_pk_add_f32 v[70:71], v[70:71], v[78:79]
    v_pk_add_f32 v[80:81], v[80:81], v[88:89]
    v_pk_add_f32 v[82:83], v[82:83], v[90:91]
    v_pk_add_f32 v[84:85], v[84:85], v[92:93]
    v_pk_add_f32 v[86:87], v[86:87], v[94:95]
    v_pk_add_f32 v[240:241], v[64:65], v[80:81]
    v_pk_add_f32 v[242:243], v[66:67], v[82:83]
    v_pk_add_f32 v[244:245], v[68:69], v[84:85]
    v_pk_add_f32 v[246:247], v[70:71], v[86:87]
    v_pk_add_f32 v[248:249], v[32:33], v[40:41]
    v_pk_add_f32 v[250:251], v[34:35], v[42:43]
    v_pk_add_f32 v[252:253], v[36:37], v[44:45]
    v_pk_add_f32 v[254:255], v[38:39], v[46:47]
    v_pk_mov_b32 v[32:33], v[56:57], v[56:57] op_sel:[0,1]
    v_pk_mov_b32 v[34:35], v[58:59], v[58:59] op_sel:[0,1]
    v_pk_mov_b32 v[36:37], v[60:61], v[60:61] op_sel:[0,1]
    v_pk_mov_b32 v[38:39], v[62:63], v[62:63] op_sel:[0,1]
    s_branch L_gpoll
L_gh1:
    v_pk_add_f32 v[64:65], v[64:65], v[72:73]
    v_pk_add_f32 v[66:67], v[66:67], v[74:75]
    v_pk_add_f32 v[68:69], v[68:69], v[76:77]
    v_pk_add_f32 v[70:71], v[70:71], v[78:79]
    v_pk_add_f32 v[80:81], v[80:81], v[88:89]
    v_pk_add_f32 v[82:83], v[82:83], v[90:91]
    v_pk_add_f32 v[84:85], v[84:85], v[92:93]
    v_pk_add_f32 v[86:87], v[86:87], v[94:95]
    v_pk_add_f32 v[240:241], v[64:65], v[80:81]
    v_pk_add_f32 v[242:243], v[66:67], v[82:83]
    v_pk_add_f32 v[244:245], v[68:69], v[84:85]
    v_pk_add_f32 v[246:247], v[70:71], v[86:87]
    v_pk_add_f32 v[248:249], v[48:49], v[56:57]
    v_pk_add_f32 v[250:251], v[50:51], v[58:59]
    v_pk_add_f32 v[252:253], v[52:53], v[60:61]
    v_pk_add_f32 v[254:255], v[54:55], v[62:63]
    s_branch L_gpoll
L_gh0:
    v_pk_add_f32 v[64:65], v[64:65], v[72:73]
    v_pk_add_f32 v[66:67], v[66:67], v[74:75]
    v_pk_add_f32 v[68:69], v[68:69], v[76:77]
    v_pk_add_f32 v[70:71], v[70:71], v[78:79]
    v_pk_add_f32 v[80:81], v[80:81], v[88:89]
    v_pk_add_f32 v[82:83], v[82:83], v[90:91]
    v_pk_add_f32 v[84:85], v[84:85], v[92:93]
    v_pk_add_f32 v[86:87], v[86:87], v[94:95]
    v_pk_add_f32 v[240:241], v[64:65], v[80:81]
    v_pk_add_f32 v[242:243], v[66:67], v[82:83]
    v_pk_add_f32 v[244:245], v[68:69], v[84:85]
    v_pk_add_f32 v[246:247], v[70:71], v[86:87]
    v_pk_add_f32 v[248:249], v[48:49], v[56:57]
    v_pk_add_f32 v[250:251], v[50:51], v[58:59]
    v_pk_add_f32 v[252:253], v[52:53], v[60:61]
    v_pk_add_f32 v[254:255], v[54:55], v[62:63]
    v_pk_mov_b32 v[32:33], v[40:41], v[40:41] op_sel:[0,1]
    v_pk_mov_b32 v[34:35], v[42:43], v[42:43] op_sel:[0,1]
    v_pk_mov_b32 v[36:37], v[44:45], v[44:45] op_sel:[0,1]
    v_pk_mov_b32 v[38:39], v[46:47], v[46:47] op_sel:[0,1]
L_gpoll:
    v_pk_mov_b32 v[40:41], v[248:249], v[248:249] op_sel:[0,1]
    v_pk_mov_b32 v[42:43], v[250:251], v[250:251] op_sel:[0,1]
    v_pk_mov_b32 v[44:45], v[252:253], v[252:253] op_sel:[0,1]
    v_pk_mov_b32 v[46:47], v[254:255], v[254:255] op_sel:[0,1]
    v_pk_mov_b32 v[48:49], v[240:241], v[240:241] op_sel:[0,1]
    v_pk_mov_b32 v[50:51], v[242:243], v[242:243] op_sel:[0,1]
    v_pk_mov_b32 v[52:53], v[244:245], v[244:245] op_sel:[0,1]
    v_pk_mov_b32 v[54:55], v[246:247], v[246:247] op_sel:[0,1]
L_gploop:
    buffer_load_dwordx4 v[24:27], v22, s[56:59], s12 offen sc1
    s_waitcnt vmcnt(1)
    v_xor_b32 v19, s43, v19
    v_cmp_lt_u32 vcc, 0xffff, v19
    s_cbranch_vccz L_gx
    buffer_load_dwordx4 v[16:19], v22, s[56:59], s12 offen sc1
    s_waitcnt vmcnt(1)
    v_xor_b32 v27, s43, v27
    v_cmp_lt_u32 vcc, 0xffff, v27
    s_cbranch_vccz L_gy
    s_sub_u32 s71, s71, 1
    s_cmp_lg_u32 s71, 0
    s_cbranch_scc1 L_gploop
L_gy:
    v_lshlrev_b32 v56, 16, v24
    v_and_b32 v57, 0xffff0000, v24
    v_lshlrev_b32 v58, 16, v25
    v_and_b32 v59, 0xffff0000, v25
    v_lshlrev_b32 v60, 16, v26
    v_and_b32 v61, 0xffff0000, v26
    v_lshlrev_b32 v62, 16, v27
    s_branch L_gfin
L_gdone:
    v_pk_add_f32 v[32:33], v[32:33], v[40:41]
    v_pk_add_f32 v[34:35], v[34:35], v[42:43]
    v_pk_add_f32 v[36:37], v[36:37], v[44:45]
    v_pk_add_f32 v[38:39], v[38:39], v[46:47]
    v_pk_add_f32 v[48:49], v[48:49], v[56:57]
    v_pk_add_f32 v[50:51], v[50:51], v[58:59]
    v_pk_add_f32 v[52:53], v[52:53], v[60:61]
    v_pk_add_f32 v[54:55], v[54:55], v[62:63]
    v_pk_add_f32 v[64:65], v[64:65], v[72:73]
    v_pk_add_f32 v[66:67], v[66:67], v[74:75]
    v_pk_add_f32 v[68:69], v[68:69], v[76:77]
    v_pk_add_f32 v[70:71], v[70:71], v[78:79]
    v_pk_add_f32 v[80:81], v[80:81], v[88:89]
    v_pk_add_f32 v[82:83], v[82:83], v[90:91]
    v_pk_add_f32 v[84:85], v[84:85], v[92:93]
    v_pk_add_f32 v[86:87], v[86:87], v[94:95]
    v_pk_add_f32 v[32:33], v[32:33], v[48:49]
    v_pk_add_f32 v[34:35], v[34:35], v[50:51]
    v_pk_add_f32 v[36:37], v[36:37], v[52:53]
    v_pk_add_f32 v[38:39], v[38:39], v[54:55]
    v_pk_add_f32 v[64:65], v[64:65], v[80:81]
    v_pk_add_f32 v[66:67], v[66:67], v[82:83]
    v_pk_add_f32 v[68:69], v[68:69], v[84:85]
    v_pk_add_f32 v[70:71], v[70:71], v[86:87]
    v_pk_add_f32 v[32:33], v[32:33], v[64:65]
    v_pk_add_f32 v[34:35], v[34:35], v[66:67]
    v_pk_add_f32 v[36:37], v[36:37], v[68:69]
    v_pk_add_f32 v[38:39], v[38:39], v[70:71]
    s_branch L_gend
L_gx:
    v_lshlrev_b32 v56, 16, v16
    v_and_b32 v57, 0xffff0000, v16
    v_lshlrev_b32 v58, 16, v17
    v_and_b32 v59, 0xffff0000, v17
    v_lshlrev_b32 v60, 16, v18
    v_and_b32 v61, 0xffff0000, v18
    v_lshlrev_b32 v62, 16, v19
L_gfin:
    v_pk_add_f32 v[32:33], v[32:33], v[56:57]
    v_pk_add_f32 v[34:35], v[34:35], v[58:59]
    v_pk_add_f32 v[36:37], v[36:37], v[60:61]
    v_pk_add_f32 v[38:39], v[38:39], v[62:63]
    v_pk_add_f32 v[32:33], v[32:33], v[40:41]
    v_pk_add_f32 v[34:35], v[34:35], v[42:43]
    v_pk_add_f32 v[36:37], v[36:37], v[44:45]
    v_pk_add_f32 v[38:39], v[38:39], v[46:47]
    v_pk_add_f32 v[32:33], v[32:33], v[48:49]
    v_pk_add_f32 v[34:35], v[34:35], v[50:51]
    v_pk_add_f32 v[36:37], v[36:37], v[52:53]
    v_pk_add_f32 v[38:39], v[38:39], v[54:55]
L_gend:
    ds_write_b128 v232, v[32:35] offset:31552
    ds_write_b128 v232, v[36:39] offset:32576
    s_waitcnt lgkmcnt(0)
    s_barrier
    ds_read_b128 v[32:35], v22 offset:31552
    ds_read_b128 v[36:39], v22 offset:32576
    ds_read_b128 v[40:43], v22 offset:33600
    ds_read_b128 v[44:47], v22 offset:34624
    ds_read_b128 v[48:51], v22 offset:35648
    ds_read_b128 v[52:55], v22 offset:36672
    ds_read_b128 v[56:59], v22 offset:37696
    ds_read_b128 v[60:63], v22 offset:38720
    s_add_u32 s12, s8, s9
    s_cmp_lg_u32 s12, 0
    s_cbranch_scc1 L_noupd_198
    s_lshl_b32 s12, s7, 7
    v_mov_b32 v28, s12
    s_mov_b64 exec, 1
    v_mov_b32 v29, s42
    global_store_dword v28, v29, s[40:41] offset:2048 sc1
    s_mov_b64 exec, -1
L_noupd_198:
    s_waitcnt lgkmcnt(4)
    v_pk_add_f32 v[32:33], v[32:33], v[40:41]
    v_pk_add_f32 v[34:35], v[34:35], v[42:43]
    v_pk_add_f32 v[36:37], v[36:37], v[44:45]
    v_pk_add_f32 v[38:39], v[38:39], v[46:47]
    s_waitcnt lgkmcnt(0)
    v_pk_add_f32 v[48:49], v[48:49], v[56:57]
    v_pk_add_f32 v[50:51], v[50:51], v[58:59]
    v_pk_add_f32 v[52:53], v[52:53], v[60:61]
    v_pk_add_f32 v[54:55], v[54:55], v[62:63]
    v_pk_add_f32 v[32:33], v[32:33], v[48:49]
    v_pk_add_f32 v[34:35], v[34:35], v[50:51]
    v_pk_add_f32 v[36:37], v[36:37], v[52:53]
    v_pk_add_f32 v[38:39], v[38:39], v[54:55]
    v_pk_add_f32 v[32:33], v[32:33], v[216:217]
    v_cvt_pk_bf16_f32 v33, v32, v33
    v_lshlrev_b32 v32, 16, v33
    v_and_b32 v33, 0xffff0000, v33
    v_pk_add_f32 v[34:35], v[34:35], v[218:219]
    v_cvt_pk_bf16_f32 v35, v34, v35
    v_lshlrev_b32 v34, 16, v35
    v_and_b32 v35, 0xffff0000, v35
    v_pk_add_f32 v[36:37], v[36:37], v[220:221]
    v_cvt_pk_bf16_f32 v37, v36, v37
    v_lshlrev_b32 v36, 16, v37
    v_and_b32 v37, 0xffff0000, v37
    v_add_f32 v38, v38, v222
    v_cvt_pk_bf16_f32 v38, v38, v38
    v_and_b32 v38, 0xffff0000, v38
    v_mov_b32 v39, 0
    ds_write2_b32 v223, v32, v33 offset0:0 offset1:1
    ds_write2_b32 v223, v34, v35 offset0:2 offset1:3
    ds_write2_b32 v223, v36, v37 offset0:4 offset1:5
    ds_write_b32 v223, v38 offset:24
    v_pk_add_f32 v[64:65], v[32:33], v[34:35]
    v_pk_mul_f32 v[66:67], v[32:33], v[32:33]
    v_pk_add_f32 v[64:65], v[64:65], v[36:37]
    v_pk_fma_f32 v[66:67], v[34:35], v[34:35], v[66:67]
    v_pk_add_f32 v[64:65], v[64:65], v[38:39]
    v_pk_fma_f32 v[66:67], v[36:37], v[36:37], v[66:67]
    v_add_f32 v64, v64, v65
    v_pk_fma_f32 v[66:67], v[38:39], v[38:39], v[66:67]
    v_add_f32 v66, v66, v67
    s_waitcnt lgkmcnt(0)
    ds_read2_b32 v[48:49], v228 offset0:0 offset1:2
    ds_read2_b32 v[50:51], v228 offset0:16 offset1:18
    ds_read2_b32 v[52:53], v228 offset0:32 offset1:34
    ds_read2_b32 v[54:55], v228 offset0:48 offset1:50
    ds_read2_b32 v[56:57], v228 offset0:64 offset1:66
    ds_read2_b32 v[58:59], v228 offset0:80 offset1:82
    ds_read2_b32 v[60:61], v228 offset0:96 offset1:98
    v_add_f32_dpp v64, v64, v64 row_ror:8 row_mask:0xf bank_mask:0xf
    s_nop 0
    v_add_f32_dpp v66, v66, v66 row_ror:8 row_mask:0xf bank_mask:0xf
    v_add_f32_dpp v64, v64, v64 row_ror:4 row_mask:0xf bank_mask:0xf
    s_nop 0
    v_add_f32_dpp v66, v66, v66 row_ror:4 row_mask:0xf bank_mask:0xf
    v_add_f32_dpp v64, v64, v64 row_ror:2 row_mask:0xf bank_mask:0xf
    s_nop 0
    v_add_f32_dpp v66, v66, v66 row_ror:2 row_mask:0xf bank_mask:0xf
    v_add_f32_dpp v64, v64, v64 row_ror:1 row_mask:0xf bank_mask:0xf
    s_nop 0
    v_add_f32_dpp v66, v66, v66 row_ror:1 row_mask:0xf bank_mask:0xf
    v_mov_b32 v65, v64
    v_mov_b32 v67, v66
    s_nop 0
    s_waitcnt lgkmcnt(6)
    v_and_b32 v72, v48, v225
    v_and_b32 v73, v48, v226
    v_permlane16_swap_b32 v64, v65
    v_and_b32 v74, v49, v225
    v_and_b32 v75, v49, v226
    v_permlane16_swap_b32 v66, v67
    s_waitcnt lgkmcnt(5)
    v_and_b32 v76, v50, v225
    v_and_b32 v77, v50, v226
    v_add_f32 v64, v64, v65
    v_and_b32 v78, v51, v225
    v_and_b32 v79, v51, v226
    v_add_f32 v66, v66, v67
    v_smfmac_f32_16x16x64_bf16 v[8:11], v[72:75], v[96:103], v227
    s_waitcnt lgkmcnt(4)
    v_and_b32 v72, v52, v225
    v_mov_b32 v65, v64
    v_and_b32 v73, v52, v226
    v_and_b32 v74, v53, v225
    v_mov_b32 v67, v66
    v_and_b32 v75, v53, v226
    v_smfmac_f32_16x16x64_bf16 v[8:11], v[76:79], v[104:111], v227
    v_permlane32_swap_b32 v64, v65
    s_waitcnt lgkmcnt(3)
    v_and_b32 v76, v54, v225
    v_and_b32 v77, v54, v226
    v_permlane32_swap_b32 v66, v67
    v_and_b32 v78, v55, v225
    v_and_b32 v79, v55, v226
    v_add_f32 v64, v64, v65
    v_smfmac_f32_16x16x64_bf16 v[8:11], v[72:75], v[112:119], v227
    s_waitcnt lgkmcnt(2)
    v_and_b32 v72, v56, v225
    v_add_f32 v66, v66, v67
    v_and_b32 v73, v56, v226
    v_and_b32 v74, v57, v225
    v_mul_f32 v68, 0x3b124925, v64
    v_and_b32 v75, v57, v226
    v_smfmac_f32_16x16x64_bf16 v[8:11], v[76:79], v[120:127], v227
    v_mul_f32 v66, 0x3b124925, v66
    s_waitcnt lgkmcnt(1)
    v_and_b32 v76, v58, v225
    v_and_b32 v77, v58, v226
    v_fma_f32 v66, -v68, v68, v66
    v_and_b32 v78, v59, v225
    v_and_b32 v79, v59, v226
    v_max_f32 v66, 0, v66
    v_smfmac_f32_16x16x64_bf16 v[8:11], v[72:75], v[128:135], v227
    s_waitcnt lgkmcnt(0)
    v_and_b32 v72, v60, v225
    v_add_f32 v66, 0x3727c5ac, v66
    v_and_b32 v73, v60, v226
    v_and_b32 v74, v61, v225
    v_rsq_f32 v70, v66
    v_and_b32 v75, v61, v226
    v_smfmac_f32_16x16x64_bf16 v[8:11], v[76:79], v[136:143], v227
    v_pk_add_f32 v[32:33], v[32:33], v[68:69] op_sel_hi:[1,0] neg_lo:[0,1] neg_hi:[0,1]
    v_pk_add_f32 v[34:35], v[34:35], v[68:69] op_sel_hi:[1,0] neg_lo:[0,1] neg_hi:[0,1]
    v_smfmac_f32_16x16x64_bf16 v[8:11], v[72:75], v[144:151], v227
    v_pk_add_f32 v[36:37], v[36:37], v[68:69] op_sel_hi:[1,0] neg_lo:[0,1] neg_hi:[0,1]
    v_sub_f32 v38, v38, v68
    v_pk_mul_f32 v[32:33], v[32:33], v[70:71] op_sel_hi:[1,0]
    v_pk_mul_f32 v[34:35], v[34:35], v[70:71] op_sel_hi:[1,0]
    v_pk_mul_f32 v[36:37], v[36:37], v[70:71] op_sel_hi:[1,0]
    v_mul_f32 v38, v38, v70
    s_mov_b32 exec_lo, 0x00ff00ff
    s_mov_b32 exec_hi, 0xff00ff00
    ds_write_b128 v229, v[8:11] offset:43840
    s_mov_b64 exec, -1
    v_mov_b32 v62, v68
    v_mov_b32 v63, v70
    v_pk_add_f32 v[64:65], v[32:33], v[34:35]
    v_pk_mul_f32 v[66:67], v[32:33], v[32:33]
    v_pk_add_f32 v[64:65], v[64:65], v[36:37]
    v_pk_fma_f32 v[66:67], v[34:35], v[34:35], v[66:67]
    v_pk_add_f32 v[64:65], v[64:65], v[38:39]
    v_pk_fma_f32 v[66:67], v[36:37], v[36:37], v[66:67]
    v_add_f32 v64, v64, v65
    v_pk_fma_f32 v[66:67], v[38:39], v[38:39], v[66:67]
    v_add_f32 v66, v66, v67
    v_add_f32_dpp v64, v64, v64 row_ror:8 row_mask:0xf bank_mask:0xf
    s_nop 0
    v_add_f32_dpp v66, v66, v66 row_ror:8 row_mask:0xf bank_mask:0xf
    s_waitcnt lgkmcnt(0)
    s_barrier
    ds_read2st64_b32 v[72:73], v230 offset0:0 offset1:1
    ds_read2st64_b32 v[74:75], v230 offset0:2 offset1:3
    ds_read2st64_b32 v[76:77], v230 offset0:4 offset1:5
    ds_read2st64_b32 v[78:79], v230 offset0:6 offset1:7
    v_add_f32_dpp v64, v64, v64 row_ror:4 row_mask:0xf bank_mask:0xf
    s_nop 0
    v_add_f32_dpp v66, v66, v66 row_ror:4 row_mask:0xf bank_mask:0xf
    v_add_f32_dpp v64, v64, v64 row_ror:2 row_mask:0xf bank_mask:0xf
    s_nop 0
    v_add_f32_dpp v66, v66, v66 row_ror:2 row_mask:0xf bank_mask:0xf
    v_add_f32_dpp v64, v64, v64 row_ror:1 row_mask:0xf bank_mask:0xf
    s_nop 0
    v_add_f32_dpp v66, v66, v66 row_ror:1 row_mask:0xf bank_mask:0xf
    v_mov_b32 v65, v64
    v_mov_b32 v67, v66
    s_nop 0
    v_permlane16_swap_b32 v64, v65
    v_permlane16_swap_b32 v66, v67
    v_add_f32 v64, v64, v65
    v_add_f32 v66, v66, v67
    v_mov_b32 v65, v64
    v_mov_b32 v67, v66
    s_nop 0
    v_permlane32_swap_b32 v64, v65
    v_permlane32_swap_b32 v66, v67
    v_add_f32 v64, v64, v65
    v_add_f32 v66, v66, v67
    v_mul_f32 v68, 0x3b124925, v64
    v_mul_f32 v66, 0x3b124925, v66
    v_fma_f32 v66, -v68, v68, v66
    v_max_f32 v66, 0, v66
    v_add_f32 v66, 0x3727c5ac, v66
    v_rsq_f32 v70, v66
    s_nop 0
    v_mul_f32 v63, v63, v70
    v_mul_f32 v68, v68, v70
    v_fmac_f32 v68, v62, v63
    v_fma_f32 v62, -v68, v236, v224
    s_waitcnt lgkmcnt(0)
    v_pk_add_f32 v[72:73], v[72:73], v[74:75]
    v_pk_add_f32 v[76:77], v[76:77], v[78:79]
    v_pk_add_f32 v[72:73], v[72:73], v[76:77]
    v_add_f32 v64, v72, v73
    v_fma_f32 v64, v63, v64, v62
    v_mul_f32 v65, v64, v64
    v_mul_f32 v65, 0x3d372713, v65
    v_fma_f32 v65, v65, v64, v64
    v_mul_f32 v65, 0xc0135761, v65
    v_exp_f32 v65, v65
    s_nop 0
    v_add_f32 v65, 1.0, v65
    v_rcp_f32 v65, v65
    s_nop 0
    v_mul_f32 v64, v64, v65
    v_cvt_pk_bf16_f32 v64, v64, v64
    s_nop 1
    v_and_b32_dpp v68, v64, v225 row_newbcast:0 row_mask:0xf bank_mask:0xf
    v_and_b32_dpp v69, v64, v226 row_newbcast:0 row_mask:0xf bank_mask:0xf
    v_and_b32_dpp v70, v64, v225 row_newbcast:8 row_mask:0xf bank_mask:0xf
    v_and_b32_dpp v71, v64, v226 row_newbcast:8 row_mask:0xf bank_mask:0xf
    v_and_b32_dpp v72, v64, v225 row_newbcast:1 row_mask:0xf bank_mask:0xf
    v_and_b32_dpp v73, v64, v226 row_newbcast:1 row_mask:0xf bank_mask:0xf
    v_and_b32_dpp v74, v64, v225 row_newbcast:9 row_mask:0xf bank_mask:0xf
    v_and_b32_dpp v75, v64, v226 row_newbcast:9 row_mask:0xf bank_mask:0xf
    v_smfmac_f32_16x16x64_bf16 v[12:15], v[68:71], v[152:159], v227
    v_and_b32_dpp v68, v64, v225 row_newbcast:2 row_mask:0xf bank_mask:0xf
    v_and_b32_dpp v69, v64, v226 row_newbcast:2 row_mask:0xf bank_mask:0xf
    v_and_b32_dpp v70, v64, v225 row_newbcast:10 row_mask:0xf bank_mask:0xf
    v_and_b32_dpp v71, v64, v226 row_newbcast:10 row_mask:0xf bank_mask:0xf
    v_smfmac_f32_16x16x64_bf16 v[12:15], v[72:75], v[160:167], v227
    v_and_b32_dpp v72, v64, v225 row_newbcast:3 row_mask:0xf bank_mask:0xf
    v_and_b32_dpp v73, v64, v226 row_newbcast:3 row_mask:0xf bank_mask:0xf
    v_and_b32_dpp v74, v64, v225 row_newbcast:11 row_mask:0xf bank_mask:0xf
    v_and_b32_dpp v75, v64, v226 row_newbcast:11 row_mask:0xf bank_mask:0xf
    v_smfmac_f32_16x16x64_bf16 v[12:15], v[68:71], v[168:175], v227
    v_and_b32_dpp v68, v64, v225 row_newbcast:4 row_mask:0xf bank_mask:0xf
    v_and_b32_dpp v69, v64, v226 row_newbcast:4 row_mask:0xf bank_mask:0xf
    v_and_b32_dpp v70, v64, v225 row_newbcast:12 row_mask:0xf bank_mask:0xf
    v_and_b32_dpp v71, v64, v226 row_newbcast:12 row_mask:0xf bank_mask:0xf
    v_smfmac_f32_16x16x64_bf16 v[12:15], v[72:75], v[176:183], v227
    v_and_b32_dpp v72, v64, v225 row_newbcast:5 row_mask:0xf bank_mask:0xf
    v_and_b32_dpp v73, v64, v226 row_newbcast:5 row_mask:0xf bank_mask:0xf
    v_and_b32_dpp v74, v64, v225 row_newbcast:13 row_mask:0xf bank_mask:0xf
    v_and_b32_dpp v75, v64, v226 row_newbcast:13 row_mask:0xf bank_mask:0xf
    v_smfmac_f32_16x16x64_bf16 v[12:15], v[68:71], v[184:191], v227
    v_and_b32_dpp v68, v64, v225 row_newbcast:6 row_mask:0xf bank_mask:0xf
    v_and_b32_dpp v69, v64, v226 row_newbcast:6 row_mask:0xf bank_mask:0xf
    v_and_b32_dpp v70, v64, v225 row_newbcast:14 row_mask:0xf bank_mask:0xf
    v_and_b32_dpp v71, v64, v226 row_newbcast:14 row_mask:0xf bank_mask:0xf
    v_smfmac_f32_16x16x64_bf16 v[12:15], v[72:75], v[192:199], v227
    v_and_b32_dpp v72, v64, v225 row_newbcast:7 row_mask:0xf bank_mask:0xf
    v_and_b32_dpp v73, v64, v226 row_newbcast:7 row_mask:0xf bank_mask:0xf
    v_and_b32_dpp v74, v64, v225 row_newbcast:15 row_mask:0xf bank_mask:0xf
    v_and_b32_dpp v75, v64, v226 row_newbcast:15 row_mask:0xf bank_mask:0xf
    v_smfmac_f32_16x16x64_bf16 v[12:15], v[68:71], v[200:207], v227
    s_nop 0
    v_smfmac_f32_16x16x64_bf16 v[12:15], v[72:75], v[208:215], v227
    s_mov_b32 exec_lo, 0x3fff3fff
    s_mov_b32 exec_hi, 0xf
    s_nop 5
    v_and_or_b32 v12, v12, v31, s68
    v_and_or_b32 v13, v13, v31, s68
    v_and_or_b32 v14, v14, v31, s68
    v_and_or_b32 v15, v15, v31, s68
    buffer_store_dwordx4 v[12:15], v231, s[60:63], s75 offen sc1
    s_branch L_vdone_180
L_nomlp_181:
    s_barrier
L_vdone_180:
L_end:
    s_endpgm
L_mon:
    ds_read_b128 v[8:11], v15 offset:46400
    s_waitcnt lgkmcnt(0)
    v_add_u32 v8, v8, v9
    v_add3_u32 v8, v8, v10, v11
    v_or_b32 v9, s86, v8
    v_readfirstlane_b32 s87, v8
    s_mov_b64 exec, 1
    global_store_dword v12, v9, s[40:41]
    s_mov_b64 exec, -1
    global_load_dword v9, v13, s[40:41] sc1
    s_cmp_eq_u32 s85, 1
    s_cbranch_scc1 L_mon2
    s_cmp_lg_u32 s85, 0
    s_cbranch_scc1 L_mon1
    buffer_load_dwordx2 v[10:11], v14, s[56:59], 0 offen offset:1800 sc1
    s_waitcnt vmcnt(0)
    v_xor_b32 v10, s68, v10
    v_xor_b32 v11, s68, v11
    v_or_b32 v10, v10, v11
    v_cmp_ne_u32 vcc, 0, v10
    s_cbranch_vccnz L_mon1
    s_mov_b32 s85, 1
    v_subrev_u32 v10, 256, v8
    v_or_b32 v10, s86, v10
    s_mov_b64 exec, 1
    global_store_dword v12, v10, s[40:41] offset:64
    s_mov_b64 exec, -1
    s_branch L_mon1
L_mon2:
    global_load_dword v10, v13, s[40:41] offset:64 sc1
    s_waitcnt vmcnt(0)
    v_xor_b32 v10, s86, v10
    v_cmp_le_u32 vcc, 0x400, v10
    s_cbranch_vccnz L_mon1
    v_add_u32_dpp v10, v10, v10 row_ror:8 row_mask:0xf bank_mask:0xf
    s_nop 1
    v_add_u32_dpp v10, v10, v10 row_ror:4 row_mask:0xf bank_mask:0xf
    s_nop 1
    v_add_u32_dpp v10, v10, v10 row_ror:2 row_mask:0xf bank_mask:0xf
    s_nop 1
    v_add_u32_dpp v10, v10, v10 row_ror:1 row_mask:0xf bank_mask:0xf
    s_nop 1
    v_readfirstlane_b32 s12, v10
    s_nop 0
    s_sub_i32 s12, s12, 576
    s_cmp_lt_i32 s12, 0
    s_movk_i32 s11, 4096
    s_cselect_b32 s83, -4096, s11
    s_abs_i32 s12, s12
    s_mul_i32 s12, s12, 9
    s_lshr_b32 s12, s12, 3
    s_add_u32 s85, s12, s87
L_mon1:
    s_cmp_ge_u32 s87, s85
    s_cselect_b32 s83, s82, s83
    s_waitcnt vmcnt(0)
    v_xor_b32 v9, s86, v9
    v_cmp_gt_u32 vcc, 0x400, v9
    s_lshl_b32 s11, s87, 4
    s_lshr_b32 s12, s87, 2
    v_cndmask_b32 v9, v8, v9, vcc
    s_nop 1
    v_add_u32_dpp v9, v9, v9 row_ror:8 row_mask:0xf bank_mask:0xf
    s_nop 1
    v_add_u32_dpp v9, v9, v9 row_ror:4 row_mask:0xf bank_mask:0xf
    s_nop 1
    v_add_u32_dpp v9, v9, v9 row_ror:2 row_mask:0xf bank_mask:0xf
    s_nop 1
    v_add_u32_dpp v9, v9, v9 row_ror:1 row_mask:0xf bank_mask:0xf
    s_add_i32 s11, s11, s83
    s_add_u32 s12, s12, 8
    v_cmp_lt_i32 vcc, s11, v9
    s_max_u32 s12, s12, s84
    v_mov_b32 v10, s84
    v_mov_b32 v11, s12
    v_cndmask_b32 v10, v10, v11, vcc
    ds_write_b32 v15, v10 offset:46416
    s_setpc_b64 s[14:15]
    s_endpgm
.section .rodata,"a"
.p2align 6
.amdhsa_kernel sequential_preLN__mha_block_cached__mixer_channel_mlp__decode_kernel
.amdhsa_next_free_vgpr 256
.amdhsa_next_free_sgpr 102
.amdhsa_accum_offset 256
.amdhsa_group_segment_fixed_size 0
.amdhsa_kernarg_size 104
.amdhsa_user_sgpr_count 2
.amdhsa_user_sgpr_kernarg_segment_ptr 1
.amdhsa_system_sgpr_workgroup_id_x 1
.amdhsa_float_denorm_mode_32 3
.end_amdhsa_kernel
```
